```python
import torch

def _softmax(x, axis=-1):
    return torch.softmax(x, dim=axis)
def _gelu(x):
    return torch.nn.functional.gelu(x, approximate="tanh")
def _silu(x):
    return torch.nn.functional.silu(x)
def _sigmoid(x):
    return torch.sigmoid(x)
def _layernorm(x, axis=-1, eps=1e-5):
    m = x.mean(dim=axis, keepdim=True)
    v = x.var(dim=axis, keepdim=True, unbiased=False)
    return (x - m) / torch.sqrt(v + eps)
def _scatter_add(tgt, idx, src, axis=0):
    return tgt.clone().index_add_(axis, idx, src)
def _segment_sum(src, seg, n):
    out = torch.zeros((n,) + src.shape[1:], dtype=src.dtype)
    return out.index_add_(0, seg, src)
def _pad(x, pw):
    flat = tuple(v for pair in reversed(pw) for v in pair)
    return torch.nn.functional.pad(x, flat)

kernel_name = 'gated_mix__softmax_full_mha__softmax_full_mha__prompt'

def setup_inputs():

    _w = (lambda a: (lambda t: t.to(torch.bfloat16) if t.is_floating_point() else t)(torch.as_tensor(a)))
    def _A_setup():
        B, S, D = 1, 2048, 448
        return {
            "x": _w((lambda *s: torch.randn(*s, dtype=torch.bfloat16) * 0.05)(B, S, D)),
            "wqkv": _w((lambda *s: torch.randn(*s, dtype=torch.bfloat16) * 0.8)(D, 3 * D)),
            "wo": _w((lambda *s: torch.randn(*s, dtype=torch.bfloat16) * 0.05)(D, D)),
        }
    _A_in = _A_setup()

    def _B_setup():
        B, S, D = 1, 2048, 448
        return {
            "x": _w((lambda *s: torch.randn(*s, dtype=torch.bfloat16) * 0.05)(B, S, D)),
            "wqkv": _w((lambda *s: torch.randn(*s, dtype=torch.bfloat16) * 0.8)(D, 3 * D)),
            "wo": _w((lambda *s: torch.randn(*s, dtype=torch.bfloat16) * 0.05)(D, D)),
        }
    _B_in = _B_setup()

    return {
        "A_x": _A_in["x"],
        "A_wqkv": _A_in["wqkv"],
        "A_wo": _A_in["wo"],
        "B_x": _B_in["x"],
        "B_wqkv": _B_in["wqkv"],
        "B_wo": _B_in["wo"],
        "gate_w": _w((lambda *s: torch.randn(*s, dtype=torch.bfloat16) * 0.05)(448) * 16.0),
    }

def reference(A_x, A_wqkv, A_wo, B_x, B_wqkv, B_wo, gate_w):
    def _A_ref(x, wqkv, wo):
        B, S, D = x.shape
        H = 16; Dh = D // H
        qkv = (lambda x, *d: x.permute(*d))((x @ wqkv).reshape(B, S, 3, H, Dh), 2, 0, 3, 1, 4)
        q, k, v = qkv[0], qkv[1], qkv[2]
        scale = Dh ** -0.5
        scores = torch.einsum("bhqd,bhkd->bhqk", q, k) * scale
        p = _softmax(scores, axis=-1)
        o = torch.einsum("bhqk,bhkd->bhqd", p, v)
        return (lambda x, *d: x.permute(*d))(o, 0, 2, 1, 3).reshape(B, S, D) @ wo

    def _B_ref(x, wqkv, wo):
        B, S, D = x.shape
        H = 16; Dh = D // H
        qkv = (lambda x, *d: x.permute(*d))((x @ wqkv).reshape(B, S, 3, H, Dh), 2, 0, 3, 1, 4)
        q, k, v = qkv[0], qkv[1], qkv[2]
        scale = Dh ** -0.5
        scores = torch.einsum("bhqd,bhkd->bhqk", q, k) * scale
        p = _softmax(scores, axis=-1)
        o = torch.einsum("bhqk,bhkd->bhqd", p, v)
        return (lambda x, *d: x.permute(*d))(o, 0, 2, 1, 3).reshape(B, S, D) @ wo

    x = A_x
    g = _sigmoid((x * gate_w).sum(-1, keepdims=True))
    a = _A_ref(x, A_wqkv, A_wo)
    b = _B_ref(x, B_wqkv, B_wo)
    return g * a + (1 - g) * b
```

```asm
; @launch grid=(256,1,1) block=(512,1,1) lds=163840
.amdgcn_target "amdgcn-amd-amdhsa--gfx950"
.text
.globl gated_mix__softmax_full_mha__softmax_full_mha__prompt_kernel
.p2align 8
.type gated_mix__softmax_full_mha__softmax_full_mha__prompt_kernel,@function
gated_mix__softmax_full_mha__softmax_full_mha__prompt_kernel:
    s_cmp_ge_u32 s2, 256
    s_cbranch_scc1 L_ka_end
    s_load_dwordx4 s[4:7], s[0:1], 0
    s_load_dwordx2 s[8:9], s[0:1], 32
    s_load_dwordx2 s[10:11], s[0:1], 48
    s_load_dwordx4 s[28:31], s[0:1], 64
    v_lshrrev_b32 v1, 6, v0
    v_and_b32 v2, 63, v0
    v_readfirstlane_b32 s35, v1
    s_and_b32 s40, s2, 7
    s_lshr_b32 s41, s2, 3
    s_and_b32 s66, s41, 3
    s_lshl_b32 s32, s40, 2
    s_add_u32 s32, s32, s66
    s_lshr_b32 s33, s41, 2
    s_and_b32 s34, s32, 15
    s_add_u32 s37, s33, s40
    s_cmp_ge_u32 s37, 7
    s_cselect_b32 s41, 7, 0
    s_sub_u32 s37, s37, s41
    s_cmp_ge_u32 s37, 7
    s_cselect_b32 s41, 7, 0
    s_sub_u32 s37, s37, s41
    v_lshlrev_b32 v1, 4, v2
    v_and_b32 v3, 31, v2
    v_lshrrev_b32 v4, 5, v2
    v_lshrrev_b32 v5, 2, v3
    v_and_b32 v6, 3, v2
    v_mul_u32_u24 v7, 2688, v5
    v_lshl_add_u32 v7, v6, 4, v7
    v_mov_b32 v8, v7
    v_mul_u32_u24 v9, 896, v4
    v_add_u32 v7, v7, v9
    v_add_u32 v7, 896, v7
    v_lshrrev_b32 v5, 3, v2
    v_mul_u32_u24 v9, 896, v5
    v_and_b32 v5, 7, v2
    v_lshrrev_b32 v11, 4, v2
    v_xor_b32 v5, v5, v11
    v_xor_b32 v11, 4, v5
    v_lshl_add_u32 v10, v11, 4, v9
    v_lshl_add_u32 v9, v5, 4, v9
    v_lshlrev_b32 v225, 2, v3
    s_lshl_b32 s49, s35, 12
    s_lshl_b32 s36, s33, 3
    s_add_u32 s36, s36, s35
    s_mul_i32 s39, s36, 28672
    s_add_u32 s51, s39, 896
    s_lshl_b32 s41, s37, 7
    s_add_u32 s39, s39, s41
    s_lshl_b32 s3, s32, 7
    s_add_u32 s3, s3, 12582912
    s_mov_b32 s65, 0
    s_mul_i32 s40, s34, 56
    s_mul_i32 s38, s35, 21504
    s_add_u32 s38, s38, s40
    s_add_u32 s50, s38, 1204224
    s_mul_i32 s41, s37, 172032
    s_add_u32 s38, s38, s41
    s_lshl_b32 s42, s35, 9
    s_cmp_ge_u32 s32, 16
    s_waitcnt lgkmcnt(0)
    s_cselect_b32 s6, s8, s6
    s_cselect_b32 s7, s9, s7
    s_mov_b32 s12, s4
    s_mov_b32 s13, s5
    s_mov_b32 s14, 1835008
    s_mov_b32 s15, 0x00020000
    s_mov_b32 s16, s6
    s_mov_b32 s17, s7
    s_mov_b32 s18, 1204224
    s_mov_b32 s19, 0x00020000
    s_mov_b32 s24, s30
    s_mov_b32 s25, s31
    s_mov_b32 s26, 25165824
    s_mov_b32 s27, 0x00020000
    s_cmp_lg_u32 s35, s65
    s_cbranch_scc1 L_ka_nosnap
    buffer_load_dword v224, v225, s[24:27], s3 offen sc1
L_ka_nosnap:
    s_lshl_b32 s41, s42, 1
    s_add_u32 m0, s41, 98304
    s_nop 0
    buffer_load_dwordx4 v7, s[16:19], s38 offen lds
    s_add_u32 s38, s38, 172032
    s_cmp_ge_u32 s38, s50
    s_cselect_b32 s41, 1204224, 0
    s_sub_u32 s38, s38, s41
    s_add_u32 m0, s49, 0
    s_nop 0
    buffer_load_dwordx4 v9, s[12:15], s39 offen lds
    s_add_u32 m0, s49, 1024
    s_add_u32 s41, s39, 7168
    buffer_load_dwordx4 v10, s[12:15], s41 offen lds
    s_add_u32 m0, s49, 2048
    s_add_u32 s41, s39, 14336
    buffer_load_dwordx4 v9, s[12:15], s41 offen lds
    s_add_u32 m0, s49, 3072
    s_add_u32 s41, s39, 21504
    buffer_load_dwordx4 v10, s[12:15], s41 offen lds
    s_add_u32 s39, s39, 128
    s_cmp_ge_u32 s39, s51
    s_cselect_b32 s41, 896, 0
    s_sub_u32 s39, s39, s41
    s_mov_b32 s56, s28
    s_mov_b32 s57, s29
    s_mov_b32 s58, 256
    s_mov_b32 s59, 0x00020000
    s_lshl_b32 s41, s32, 18
    s_add_u32 s20, s30, s41
    s_addc_u32 s21, s31, 0
    s_mov_b32 s22, 262144
    s_mov_b32 s23, 0x00020000
    s_lshl_b32 s63, s32, 3
    v_bfe_u32 v5, v3, 1, 3
    v_lshlrev_b32 v11, 2, v4
    v_xor_b32 v5, v5, v11
    v_lshlrev_b32 v11, 7, v3
    v_add_u32 v11, s49, v11
    v_xor_b32 v12, 0, v5
    v_lshl_add_u32 v200, v12, 4, v11
    v_xor_b32 v12, 1, v5
    v_lshl_add_u32 v201, v12, 4, v11
    v_xor_b32 v12, 2, v5
    v_lshl_add_u32 v202, v12, 4, v11
    v_xor_b32 v12, 3, v5
    v_lshl_add_u32 v203, v12, 4, v11
    v_add_u32 v241, 32768, v200
    v_add_u32 v242, 32768, v201
    v_add_u32 v243, 32768, v202
    v_add_u32 v244, 32768, v203
    v_bfe_u32 v15, v2, 2, 2
    v_lshlrev_b32 v14, 6, v15
    v_bfe_u32 v15, v2, 4, 1
    v_lshl_add_u32 v14, v15, 5, v14
    v_lshl_add_u32 v14, v6, 3, v14
    v_lshl_add_u32 v15, v4, 11, v14
    v_add_u32 v15, 131072, v15
    v_lshl_add_u32 v14, v4, 12, v14
    v_add_u32 v14, 98304, v14
    s_lshr_b32 s43, s35, 2
    s_and_b32 s44, s35, 3
    s_cmp_ge_u32 s32, 16
    s_cselect_b32 s47, -1.0, 1.0
    s_cselect_b32 s48, 1.0, 0
    v_mov_b32 v16, 0
    v_mov_b32 v17, 0
    v_mov_b32 v18, 0
    v_mov_b32 v19, 0
    v_mov_b32 v20, 0
    v_mov_b32 v21, 0
    v_mov_b32 v22, 0
    v_mov_b32 v23, 0
    v_mov_b32 v24, 0
    v_mov_b32 v25, 0
    v_mov_b32 v26, 0
    v_mov_b32 v27, 0
    v_mov_b32 v28, 0
    v_mov_b32 v29, 0
    v_mov_b32 v30, 0
    v_mov_b32 v31, 0
    v_mov_b32 v32, 0
    v_mov_b32 v33, 0
    v_mov_b32 v34, 0
    v_mov_b32 v35, 0
    v_mov_b32 v36, 0
    v_mov_b32 v37, 0
    v_mov_b32 v38, 0
    v_mov_b32 v39, 0
    v_mov_b32 v40, 0
    v_mov_b32 v41, 0
    v_mov_b32 v42, 0
    v_mov_b32 v43, 0
    v_mov_b32 v44, 0
    v_mov_b32 v45, 0
    v_mov_b32 v46, 0
    v_mov_b32 v47, 0
    v_mov_b32 v48, 0
    v_mov_b32 v49, 0
    v_mov_b32 v50, 0
    v_mov_b32 v51, 0
    v_mov_b32 v52, 0
    v_mov_b32 v53, 0
    v_mov_b32 v54, 0
    v_mov_b32 v55, 0
    v_mov_b32 v56, 0
    v_mov_b32 v57, 0
    v_mov_b32 v58, 0
    v_mov_b32 v59, 0
    v_mov_b32 v60, 0
    v_mov_b32 v61, 0
    v_mov_b32 v62, 0
    v_mov_b32 v63, 0
    v_mov_b32 v207, 0
    v_mov_b32 v5, 159744
    ds_write_b32 v5, v207
    ds_write_b32 v5, v207 offset:64
    s_mov_b32 s52, s10
    s_mov_b32 s53, s11
    s_mov_b32 s54, 896
    s_mov_b32 s55, 0x00020000
    v_lshrrev_b32 v12, 3, v2
    v_min_u32 v12, 6, v12
    v_and_b32 v204, 7, v2
    v_lshlrev_b32 v13, 12, v12
    v_lshl_add_u32 v13, v204, 6, v13
    s_add_u32 s41, s42, 131128
    v_add_u32 v13, s41, v13
    v_add_u32 v12, s37, v12
    v_subrev_u32 v11, 7, v12
    v_min_u32 v12, v12, v11
    v_lshl_add_u32 v12, v12, 6, v204
    s_lshl_b32 s41, s35, 3
    v_add_u32 v12, s41, v12
    v_lshlrev_b32 v12, 1, v12
    buffer_load_ushort v206, v12, s[52:55], 0 offen
    ds_write_b32 v5, v207 offset:68
    s_lshr_b32 s8, s2, 5
    s_min_u32 s8, s8, 6
    s_and_b32 s44, s2, 7
    s_lshl_b32 s44, s44, 2
    s_bfe_u32 s41, s2, 0x20003
    s_add_u32 s44, s44, s41
    s_lshl_b32 s9, s44, 1
    s_and_b32 s41, s35, 1
    s_add_u32 s9, s9, s41
    s_lshr_b32 s10, s35, 1
    s_lshl_b32 s41, s44, 8
    v_lshl_add_u32 v239, v2, 2, s41
    ds_write_b64 v5, v[16:17] offset:80
    s_mov_b32 s41, s36
    s_lshl_b32 s64, s41, 16
    s_lshl_b32 s11, s32, 11
    s_add_u32 s64, s64, s11
    s_add_u32 s64, s64, 8388608
    s_lshl_b32 s41, s41, 7
    s_lshl_b32 s11, s32, 2
    s_add_u32 s41, s41, s11
    v_mov_b32 v234, s41
    s_mov_b32 s11, 12648448
    s_cmp_lg_u32 s35, s65
    s_cbranch_scc1 L_ka_nosnap3
    buffer_load_dword v240, v239, s[24:27], s11 offen sc1
L_ka_nosnap3:
    s_mov_b64 exec, 1
    buffer_load_dword v233, v234, s[24:27], s11 offen sc1
    s_mov_b64 exec, -1
    s_barrier
    s_lshl_b32 s41, s42, 1
    s_add_u32 m0, s41, 106496
    s_nop 0
    buffer_load_dwordx4 v7, s[16:19], s38 offen lds
    s_add_u32 s38, s38, 172032
    s_cmp_ge_u32 s38, s50
    s_cselect_b32 s41, 1204224, 0
    s_sub_u32 s38, s38, s41
    s_add_u32 m0, s49, 32768
    s_nop 0
    buffer_load_dwordx4 v9, s[12:15], s39 offen lds
    s_add_u32 m0, s49, 33792
    s_add_u32 s41, s39, 7168
    buffer_load_dwordx4 v10, s[12:15], s41 offen lds
    s_add_u32 m0, s49, 34816
    s_add_u32 s41, s39, 14336
    buffer_load_dwordx4 v9, s[12:15], s41 offen lds
    s_add_u32 m0, s49, 35840
    s_add_u32 s41, s39, 21504
    buffer_load_dwordx4 v10, s[12:15], s41 offen lds
    s_add_u32 s39, s39, 128
    s_cmp_ge_u32 s39, s51
    s_cselect_b32 s41, 896, 0
    s_sub_u32 s39, s39, s41
    s_lshl_b32 s41, s42, 1
    s_add_u32 m0, s41, 114688
    s_nop 0
    buffer_load_dwordx4 v7, s[16:19], s38 offen lds
    s_add_u32 s38, s38, 172032
    s_cmp_ge_u32 s38, s50
    s_cselect_b32 s41, 1204224, 0
    s_sub_u32 s38, s38, s41
    s_add_u32 m0, s49, 65536
    s_nop 0
    buffer_load_dwordx4 v9, s[12:15], s39 offen lds
    s_add_u32 m0, s49, 66560
    s_add_u32 s41, s39, 7168
    buffer_load_dwordx4 v10, s[12:15], s41 offen lds
    s_add_u32 m0, s49, 67584
    s_add_u32 s41, s39, 14336
    buffer_load_dwordx4 v9, s[12:15], s41 offen lds
    s_add_u32 m0, s49, 68608
    s_add_u32 s41, s39, 21504
    buffer_load_dwordx4 v10, s[12:15], s41 offen lds
    s_add_u32 s39, s39, 128
    s_cmp_ge_u32 s39, s51
    s_cselect_b32 s41, 896, 0
    s_sub_u32 s39, s39, s41
    s_waitcnt vmcnt(12)
    s_cmp_lg_u32 s35, s65
    s_cbranch_scc1 L_ka_nosnap2
    v_add_u32 v11, 159872, v225
    ds_write_b32 v11, v224
L_ka_nosnap2:
    ds_read_b128 v[88:91], v200 offset:0
    ds_read_b128 v[92:95], v201 offset:0
    ds_read_b128 v[96:99], v202 offset:0
    ds_read_b128 v[100:103], v203 offset:0
    s_waitcnt lgkmcnt(0)
    s_barrier
    ds_read_b64_tr_b16 v[64:65], v14 offset:0
    ds_read_b64_tr_b16 v[66:67], v14 offset:256
    ds_read_b64_tr_b16 v[68:69], v14 offset:512
    ds_read_b64_tr_b16 v[70:71], v14 offset:768
    ds_read_b64_tr_b16 v[72:73], v14 offset:1024
    ds_read_b64_tr_b16 v[74:75], v14 offset:1280
    ds_read_b64_tr_b16 v[76:77], v14 offset:1536
    ds_read_b64_tr_b16 v[78:79], v14 offset:1792
    ds_read_b64_tr_b16 v[80:81], v14 offset:2048
    ds_read_b64_tr_b16 v[82:83], v14 offset:2304
    ds_read_b64_tr_b16 v[84:85], v14 offset:2560
    ds_read_b64_tr_b16 v[86:87], v14 offset:2816
    s_waitcnt lgkmcnt(8)
    v_mfma_f32_32x32x16_bf16 v[16:31], v[64:67], v[88:91], v[16:31]
    v_mfma_f32_32x32x16_bf16 v[32:47], v[88:91], v[68:71], v[32:47]
    s_lshl_b32 s41, s42, 1
    s_add_u32 m0, s41, 122880
    s_nop 0
    buffer_load_dwordx4 v7, s[16:19], s38 offen lds
    s_add_u32 s38, s38, 172032
    s_cmp_ge_u32 s38, s50
    s_cselect_b32 s41, 1204224, 0
    s_sub_u32 s38, s38, s41
    s_add_u32 m0, s49, 0
    s_nop 0
    buffer_load_dwordx4 v9, s[12:15], s39 offen lds
    ds_read_b64_tr_b16 v[64:65], v14 offset:3072
    ds_read_b64_tr_b16 v[66:67], v14 offset:3328
    ds_read_b64_tr_b16 v[68:69], v14 offset:3584
    ds_read_b64_tr_b16 v[70:71], v14 offset:3840
    s_waitcnt lgkmcnt(8)
    v_mfma_f32_32x32x16_bf16 v[16:31], v[72:75], v[92:95], v[16:31]
    v_mfma_f32_32x32x16_bf16 v[32:47], v[92:95], v[76:79], v[32:47]
    s_add_u32 m0, s49, 1024
    s_add_u32 s41, s39, 7168
    buffer_load_dwordx4 v10, s[12:15], s41 offen lds
    s_add_u32 m0, s49, 2048
    s_add_u32 s41, s39, 14336
    buffer_load_dwordx4 v9, s[12:15], s41 offen lds
    s_waitcnt vmcnt(9) lgkmcnt(0)
    s_barrier
    ds_read_b128 v[104:107], v200 offset:32768
    ds_read_b128 v[108:111], v201 offset:32768
    ds_read_b128 v[112:115], v202 offset:32768
    ds_read_b128 v[116:119], v203 offset:32768
    ds_read_b64_tr_b16 v[72:73], v14 offset:8192
    ds_read_b64_tr_b16 v[74:75], v14 offset:8448
    ds_read_b64_tr_b16 v[76:77], v14 offset:8704
    ds_read_b64_tr_b16 v[78:79], v14 offset:8960
    v_mfma_f32_32x32x16_bf16 v[16:31], v[80:83], v[96:99], v[16:31]
    v_mfma_f32_32x32x16_bf16 v[32:47], v[96:99], v[84:87], v[32:47]
    s_add_u32 m0, s49, 3072
    s_add_u32 s41, s39, 21504
    buffer_load_dwordx4 v10, s[12:15], s41 offen lds
    s_add_u32 s39, s39, 128
    s_cmp_ge_u32 s39, s51
    s_cselect_b32 s41, 896, 0
    s_sub_u32 s39, s39, s41
    ds_read_b64_tr_b16 v[80:81], v14 offset:9216
    ds_read_b64_tr_b16 v[82:83], v14 offset:9472
    ds_read_b64_tr_b16 v[84:85], v14 offset:9728
    ds_read_b64_tr_b16 v[86:87], v14 offset:9984
    v_mfma_f32_32x32x16_bf16 v[16:31], v[64:67], v[100:103], v[16:31]
    v_mfma_f32_32x32x16_bf16 v[32:47], v[100:103], v[68:71], v[32:47]
    ds_read_b64_tr_b16 v[64:65], v14 offset:10240
    ds_read_b64_tr_b16 v[66:67], v14 offset:10496
    ds_read_b64_tr_b16 v[68:69], v14 offset:10752
    ds_read_b64_tr_b16 v[70:71], v14 offset:11008
    s_waitcnt lgkmcnt(8)
    v_mfma_f32_32x32x16_bf16 v[16:31], v[72:75], v[104:107], v[16:31]
    v_mfma_f32_32x32x16_bf16 v[32:47], v[104:107], v[76:79], v[32:47]
    s_lshl_b32 s41, s42, 1
    s_add_u32 m0, s41, 98304
    s_nop 0
    buffer_load_dwordx4 v7, s[16:19], s38 offen lds
    s_add_u32 s38, s38, 172032
    s_cmp_ge_u32 s38, s50
    s_cselect_b32 s41, 1204224, 0
    s_sub_u32 s38, s38, s41
    s_add_u32 m0, s49, 32768
    s_nop 0
    buffer_load_dwordx4 v9, s[12:15], s39 offen lds
    ds_read_b64_tr_b16 v[72:73], v14 offset:11264
    ds_read_b64_tr_b16 v[74:75], v14 offset:11520
    ds_read_b64_tr_b16 v[76:77], v14 offset:11776
    ds_read_b64_tr_b16 v[78:79], v14 offset:12032
    s_waitcnt lgkmcnt(8)
    v_mfma_f32_32x32x16_bf16 v[16:31], v[80:83], v[108:111], v[16:31]
    v_mfma_f32_32x32x16_bf16 v[32:47], v[108:111], v[84:87], v[32:47]
    s_add_u32 m0, s49, 33792
    s_add_u32 s41, s39, 7168
    buffer_load_dwordx4 v10, s[12:15], s41 offen lds
    s_add_u32 m0, s49, 34816
    s_add_u32 s41, s39, 14336
    buffer_load_dwordx4 v9, s[12:15], s41 offen lds
    s_waitcnt vmcnt(9) lgkmcnt(0)
    s_barrier
    ds_read_b128 v[120:123], v241 offset:32768
    ds_read_b128 v[124:127], v242 offset:32768
    ds_read_b128 v[128:131], v243 offset:32768
    ds_read_b128 v[132:135], v244 offset:32768
    ds_read_b64_tr_b16 v[80:81], v14 offset:16384
    ds_read_b64_tr_b16 v[82:83], v14 offset:16640
    ds_read_b64_tr_b16 v[84:85], v14 offset:16896
    ds_read_b64_tr_b16 v[86:87], v14 offset:17152
    v_mfma_f32_32x32x16_bf16 v[16:31], v[64:67], v[112:115], v[16:31]
    v_mfma_f32_32x32x16_bf16 v[32:47], v[112:115], v[68:71], v[32:47]
    s_add_u32 m0, s49, 35840
    s_add_u32 s41, s39, 21504
    buffer_load_dwordx4 v10, s[12:15], s41 offen lds
    s_add_u32 s39, s39, 128
    s_cmp_ge_u32 s39, s51
    s_cselect_b32 s41, 896, 0
    s_sub_u32 s39, s39, s41
    ds_read_b64_tr_b16 v[64:65], v14 offset:17408
    ds_read_b64_tr_b16 v[66:67], v14 offset:17664
    ds_read_b64_tr_b16 v[68:69], v14 offset:17920
    ds_read_b64_tr_b16 v[70:71], v14 offset:18176
    v_mfma_f32_32x32x16_bf16 v[16:31], v[72:75], v[116:119], v[16:31]
    v_mfma_f32_32x32x16_bf16 v[32:47], v[116:119], v[76:79], v[32:47]
    ds_read_b64_tr_b16 v[72:73], v14 offset:18432
    ds_read_b64_tr_b16 v[74:75], v14 offset:18688
    ds_read_b64_tr_b16 v[76:77], v14 offset:18944
    ds_read_b64_tr_b16 v[78:79], v14 offset:19200
    s_waitcnt lgkmcnt(8)
    v_mfma_f32_32x32x16_bf16 v[16:31], v[80:83], v[120:123], v[16:31]
    v_mfma_f32_32x32x16_bf16 v[32:47], v[120:123], v[84:87], v[32:47]
    s_lshl_b32 s41, s42, 1
    s_add_u32 m0, s41, 106496
    s_nop 0
    buffer_load_dwordx4 v7, s[16:19], s38 offen lds
    s_add_u32 s38, s38, 172032
    s_cmp_ge_u32 s38, s50
    s_cselect_b32 s41, 1204224, 0
    s_sub_u32 s38, s38, s41
    s_add_u32 m0, s49, 65536
    s_nop 0
    buffer_load_dwordx4 v9, s[12:15], s39 offen lds
    ds_read_b64_tr_b16 v[80:81], v14 offset:19456
    ds_read_b64_tr_b16 v[82:83], v14 offset:19712
    ds_read_b64_tr_b16 v[84:85], v14 offset:19968
    ds_read_b64_tr_b16 v[86:87], v14 offset:20224
    s_waitcnt lgkmcnt(8)
    v_mfma_f32_32x32x16_bf16 v[16:31], v[64:67], v[124:127], v[16:31]
    v_mfma_f32_32x32x16_bf16 v[32:47], v[124:127], v[68:71], v[32:47]
    s_add_u32 m0, s49, 66560
    s_add_u32 s41, s39, 7168
    buffer_load_dwordx4 v10, s[12:15], s41 offen lds
    s_add_u32 m0, s49, 67584
    s_add_u32 s41, s39, 14336
    buffer_load_dwordx4 v9, s[12:15], s41 offen lds
    s_waitcnt vmcnt(9) lgkmcnt(0)
    s_barrier
    ds_read_b128 v[136:139], v200 offset:0
    ds_read_b128 v[140:143], v201 offset:0
    ds_read_b128 v[144:147], v202 offset:0
    ds_read_b128 v[148:151], v203 offset:0
    ds_read_b64_tr_b16 v[64:65], v14 offset:24576
    ds_read_b64_tr_b16 v[66:67], v14 offset:24832
    ds_read_b64_tr_b16 v[68:69], v14 offset:25088
    ds_read_b64_tr_b16 v[70:71], v14 offset:25344
    v_mfma_f32_32x32x16_bf16 v[16:31], v[72:75], v[128:131], v[16:31]
    v_mfma_f32_32x32x16_bf16 v[32:47], v[128:131], v[76:79], v[32:47]
    s_add_u32 m0, s49, 68608
    s_add_u32 s41, s39, 21504
    buffer_load_dwordx4 v10, s[12:15], s41 offen lds
    s_add_u32 s39, s39, 128
    s_cmp_ge_u32 s39, s51
    s_cselect_b32 s41, 896, 0
    s_sub_u32 s39, s39, s41
    ds_read_b64_tr_b16 v[72:73], v14 offset:25600
    ds_read_b64_tr_b16 v[74:75], v14 offset:25856
    ds_read_b64_tr_b16 v[76:77], v14 offset:26112
    ds_read_b64_tr_b16 v[78:79], v14 offset:26368
    v_mfma_f32_32x32x16_bf16 v[16:31], v[80:83], v[132:135], v[16:31]
    v_mfma_f32_32x32x16_bf16 v[32:47], v[132:135], v[84:87], v[32:47]
    ds_read_b64_tr_b16 v[80:81], v14 offset:26624
    ds_read_b64_tr_b16 v[82:83], v14 offset:26880
    ds_read_b64_tr_b16 v[84:85], v14 offset:27136
    ds_read_b64_tr_b16 v[86:87], v14 offset:27392
    s_waitcnt lgkmcnt(8)
    v_mfma_f32_32x32x16_bf16 v[16:31], v[64:67], v[136:139], v[16:31]
    v_mfma_f32_32x32x16_bf16 v[32:47], v[136:139], v[68:71], v[32:47]
    s_lshl_b32 s41, s42, 1
    s_add_u32 m0, s41, 114688
    s_nop 0
    buffer_load_dwordx4 v7, s[16:19], s38 offen lds
    s_add_u32 s38, s38, 172032
    s_cmp_ge_u32 s38, s50
    s_cselect_b32 s41, 1204224, 0
    s_sub_u32 s38, s38, s41
    s_add_u32 m0, s49, 0
    s_nop 0
    buffer_load_dwordx4 v9, s[12:15], s39 offen lds
    ds_read_b64_tr_b16 v[64:65], v14 offset:27648
    ds_read_b64_tr_b16 v[66:67], v14 offset:27904
    ds_read_b64_tr_b16 v[68:69], v14 offset:28160
    ds_read_b64_tr_b16 v[70:71], v14 offset:28416
    s_waitcnt lgkmcnt(8)
    v_mfma_f32_32x32x16_bf16 v[16:31], v[72:75], v[140:143], v[16:31]
    v_mfma_f32_32x32x16_bf16 v[32:47], v[140:143], v[76:79], v[32:47]
    s_add_u32 m0, s49, 1024
    s_add_u32 s41, s39, 7168
    buffer_load_dwordx4 v10, s[12:15], s41 offen lds
    s_add_u32 m0, s49, 2048
    s_add_u32 s41, s39, 14336
    buffer_load_dwordx4 v9, s[12:15], s41 offen lds
    s_waitcnt vmcnt(9) lgkmcnt(0)
    s_barrier
    ds_read_b128 v[152:155], v200 offset:32768
    ds_read_b128 v[156:159], v201 offset:32768
    ds_read_b128 v[160:163], v202 offset:32768
    ds_read_b128 v[164:167], v203 offset:32768
    ds_read_b64_tr_b16 v[72:73], v14 offset:0
    ds_read_b64_tr_b16 v[74:75], v14 offset:256
    ds_read_b64_tr_b16 v[76:77], v14 offset:512
    ds_read_b64_tr_b16 v[78:79], v14 offset:768
    v_mfma_f32_32x32x16_bf16 v[16:31], v[80:83], v[144:147], v[16:31]
    v_mfma_f32_32x32x16_bf16 v[32:47], v[144:147], v[84:87], v[32:47]
    s_add_u32 m0, s49, 3072
    s_add_u32 s41, s39, 21504
    buffer_load_dwordx4 v10, s[12:15], s41 offen lds
    s_add_u32 s39, s39, 128
    s_cmp_ge_u32 s39, s51
    s_cselect_b32 s41, 896, 0
    s_sub_u32 s39, s39, s41
    ds_read_b64_tr_b16 v[80:81], v14 offset:1024
    ds_read_b64_tr_b16 v[82:83], v14 offset:1280
    ds_read_b64_tr_b16 v[84:85], v14 offset:1536
    ds_read_b64_tr_b16 v[86:87], v14 offset:1792
    v_mfma_f32_32x32x16_bf16 v[16:31], v[64:67], v[148:151], v[16:31]
    v_mfma_f32_32x32x16_bf16 v[32:47], v[148:151], v[68:71], v[32:47]
    ds_read_b64_tr_b16 v[64:65], v14 offset:2048
    ds_read_b64_tr_b16 v[66:67], v14 offset:2304
    ds_read_b64_tr_b16 v[68:69], v14 offset:2560
    ds_read_b64_tr_b16 v[70:71], v14 offset:2816
    s_waitcnt lgkmcnt(8)
    v_mfma_f32_32x32x16_bf16 v[16:31], v[72:75], v[152:155], v[16:31]
    v_mfma_f32_32x32x16_bf16 v[32:47], v[152:155], v[76:79], v[32:47]
    s_add_u32 m0, s42, 131072
    s_mov_b32 exec_hi, 0
    buffer_load_dwordx4 v8, s[16:19], s38 offen lds
    s_mov_b32 exec_hi, -1
    s_add_u32 s38, s38, 172032
    s_cmp_ge_u32 s38, s50
    s_cselect_b32 s41, 1204224, 0
    s_sub_u32 s38, s38, s41
    s_add_u32 m0, s42, 135168
    s_mov_b32 exec_hi, 0
    buffer_load_dwordx4 v8, s[16:19], s38 offen lds
    s_mov_b32 exec_hi, -1
    s_add_u32 s38, s38, 172032
    s_cmp_ge_u32 s38, s50
    s_cselect_b32 s41, 1204224, 0
    s_sub_u32 s38, s38, s41
    ds_read_b64_tr_b16 v[72:73], v14 offset:3072
    ds_read_b64_tr_b16 v[74:75], v14 offset:3328
    ds_read_b64_tr_b16 v[76:77], v14 offset:3584
    ds_read_b64_tr_b16 v[78:79], v14 offset:3840
    s_waitcnt lgkmcnt(8)
    v_mfma_f32_32x32x16_bf16 v[16:31], v[80:83], v[156:159], v[16:31]
    v_mfma_f32_32x32x16_bf16 v[32:47], v[156:159], v[84:87], v[32:47]
    s_add_u32 m0, s42, 139264
    s_mov_b32 exec_hi, 0
    buffer_load_dwordx4 v8, s[16:19], s38 offen lds
    s_mov_b32 exec_hi, -1
    s_add_u32 s38, s38, 172032
    s_cmp_ge_u32 s38, s50
    s_cselect_b32 s41, 1204224, 0
    s_sub_u32 s38, s38, s41
    s_add_u32 m0, s42, 143360
    s_mov_b32 exec_hi, 0
    buffer_load_dwordx4 v8, s[16:19], s38 offen lds
    s_mov_b32 exec_hi, -1
    s_add_u32 s38, s38, 172032
    s_cmp_ge_u32 s38, s50
    s_cselect_b32 s41, 1204224, 0
    s_sub_u32 s38, s38, s41
    s_waitcnt vmcnt(9) lgkmcnt(0)
    s_barrier
    ds_read_b128 v[168:171], v241 offset:32768
    ds_read_b128 v[172:175], v242 offset:32768
    ds_read_b128 v[176:179], v243 offset:32768
    ds_read_b128 v[180:183], v244 offset:32768
    ds_read_b64_tr_b16 v[80:81], v14 offset:8192
    ds_read_b64_tr_b16 v[82:83], v14 offset:8448
    ds_read_b64_tr_b16 v[84:85], v14 offset:8704
    ds_read_b64_tr_b16 v[86:87], v14 offset:8960
    v_mfma_f32_32x32x16_bf16 v[16:31], v[64:67], v[160:163], v[16:31]
    v_mfma_f32_32x32x16_bf16 v[32:47], v[160:163], v[68:71], v[32:47]
    s_add_u32 m0, s42, 147456
    s_mov_b32 exec_hi, 0
    buffer_load_dwordx4 v8, s[16:19], s38 offen lds
    s_mov_b32 exec_hi, -1
    s_add_u32 s38, s38, 172032
    s_cmp_ge_u32 s38, s50
    s_cselect_b32 s41, 1204224, 0
    s_sub_u32 s38, s38, s41
    s_add_u32 m0, s42, 151552
    s_mov_b32 exec_hi, 0
    buffer_load_dwordx4 v8, s[16:19], s38 offen lds
    s_mov_b32 exec_hi, -1
    s_add_u32 s38, s38, 172032
    s_cmp_ge_u32 s38, s50
    s_cselect_b32 s41, 1204224, 0
    s_sub_u32 s38, s38, s41
    ds_read_b64_tr_b16 v[64:65], v14 offset:9216
    ds_read_b64_tr_b16 v[66:67], v14 offset:9472
    ds_read_b64_tr_b16 v[68:69], v14 offset:9728
    ds_read_b64_tr_b16 v[70:71], v14 offset:9984
    v_mfma_f32_32x32x16_bf16 v[16:31], v[72:75], v[164:167], v[16:31]
    v_mfma_f32_32x32x16_bf16 v[32:47], v[164:167], v[76:79], v[32:47]
    s_add_u32 m0, s42, 155648
    s_mov_b32 exec_hi, 0
    buffer_load_dwordx4 v8, s[16:19], s38 offen lds
    s_mov_b32 exec_hi, -1
    s_add_u32 s38, s38, 172032
    s_cmp_ge_u32 s38, s50
    s_cselect_b32 s41, 1204224, 0
    s_sub_u32 s38, s38, s41
    ds_read_b64_tr_b16 v[72:73], v14 offset:10240
    ds_read_b64_tr_b16 v[74:75], v14 offset:10496
    ds_read_b64_tr_b16 v[76:77], v14 offset:10752
    ds_read_b64_tr_b16 v[78:79], v14 offset:11008
    s_waitcnt lgkmcnt(8)
    v_mfma_f32_32x32x16_bf16 v[16:31], v[80:83], v[168:171], v[16:31]
    v_mfma_f32_32x32x16_bf16 v[32:47], v[168:171], v[84:87], v[32:47]
    ds_read_b64_tr_b16 v[80:81], v14 offset:11264
    ds_read_b64_tr_b16 v[82:83], v14 offset:11520
    ds_read_b64_tr_b16 v[84:85], v14 offset:11776
    ds_read_b64_tr_b16 v[86:87], v14 offset:12032
    s_waitcnt lgkmcnt(8)
    v_mfma_f32_32x32x16_bf16 v[16:31], v[64:67], v[172:175], v[16:31]
    v_mfma_f32_32x32x16_bf16 v[32:47], v[172:175], v[68:71], v[32:47]
    s_waitcnt vmcnt(7) lgkmcnt(0)
    s_barrier
    ds_read_b128 v[184:187], v200 offset:0
    ds_read_b128 v[188:191], v201 offset:0
    ds_read_b128 v[192:195], v202 offset:0
    ds_read_b128 v[196:199], v203 offset:0
    ds_read_b64_tr_b16 v[64:65], v14 offset:16384
    ds_read_b64_tr_b16 v[66:67], v14 offset:16640
    ds_read_b64_tr_b16 v[68:69], v14 offset:16896
    ds_read_b64_tr_b16 v[70:71], v14 offset:17152
    v_mfma_f32_32x32x16_bf16 v[16:31], v[72:75], v[176:179], v[16:31]
    v_mfma_f32_32x32x16_bf16 v[32:47], v[176:179], v[76:79], v[32:47]
    ds_read_b64_tr_b16 v[72:73], v14 offset:17408
    ds_read_b64_tr_b16 v[74:75], v14 offset:17664
    ds_read_b64_tr_b16 v[76:77], v14 offset:17920
    ds_read_b64_tr_b16 v[78:79], v14 offset:18176
    v_mfma_f32_32x32x16_bf16 v[16:31], v[80:83], v[180:183], v[16:31]
    v_mfma_f32_32x32x16_bf16 v[32:47], v[180:183], v[84:87], v[32:47]
    ds_read_b64_tr_b16 v[80:81], v14 offset:18432
    ds_read_b64_tr_b16 v[82:83], v14 offset:18688
    ds_read_b64_tr_b16 v[84:85], v14 offset:18944
    ds_read_b64_tr_b16 v[86:87], v14 offset:19200
    s_waitcnt lgkmcnt(8)
    v_mfma_f32_32x32x16_bf16 v[16:31], v[64:67], v[184:187], v[16:31]
    v_mfma_f32_32x32x16_bf16 v[32:47], v[184:187], v[68:71], v[32:47]
    ds_read_b64_tr_b16 v[64:65], v14 offset:19456
    ds_read_b64_tr_b16 v[66:67], v14 offset:19712
    ds_read_b64_tr_b16 v[68:69], v14 offset:19968
    ds_read_b64_tr_b16 v[70:71], v14 offset:20224
    s_waitcnt lgkmcnt(8)
    v_mfma_f32_32x32x16_bf16 v[16:31], v[72:75], v[188:191], v[16:31]
    v_mfma_f32_32x32x16_bf16 v[32:47], v[188:191], v[76:79], v[32:47]
    s_waitcnt lgkmcnt(4)
    v_mfma_f32_32x32x16_bf16 v[16:31], v[80:83], v[192:195], v[16:31]
    v_mfma_f32_32x32x16_bf16 v[32:47], v[192:195], v[84:87], v[32:47]
    s_waitcnt lgkmcnt(0)
    v_mfma_f32_32x32x16_bf16 v[16:31], v[64:67], v[196:199], v[16:31]
    v_mfma_f32_32x32x16_bf16 v[32:47], v[196:199], v[68:71], v[32:47]
    s_load_dwordx2 s[4:5], s[0:1], 16
    s_load_dwordx2 s[6:7], s[0:1], 40
    s_load_dwordx2 s[28:29], s[0:1], 56
    s_nop 1
    v_and_b32 v6, 0x13, v3
    v_bfe_u32 v7, v3, 2, 1
    v_lshl_or_b32 v6, v7, 3, v6
    v_bfe_u32 v7, v3, 3, 1
    v_lshl_or_b32 v6, v7, 2, v6
    v_lshl_add_u32 v6, v4, 5, v6
    v_lshlrev_b32 v6, 4, v6
    v_add_u32 v7, s49, v6
    v_add_u32 v8, s49, v1
    s_lshl_b32 s40, s36, 12
    v_cvt_pk_bf16_f32 v216, v32, v33
    v_cvt_pk_bf16_f32 v217, v34, v35
    v_cvt_pk_bf16_f32 v218, v36, v37
    v_cvt_pk_bf16_f32 v219, v38, v39
    v_cvt_pk_bf16_f32 v220, v40, v41
    v_cvt_pk_bf16_f32 v221, v42, v43
    v_cvt_pk_bf16_f32 v222, v44, v45
    v_cvt_pk_bf16_f32 v223, v46, v47
    s_mov_b32 exec_lo, 0x10000000
    s_mov_b32 exec_hi, 0x10000000
    v_mov_b32 v216, 0x3f803f80
    v_mov_b32 v217, 0x3f803f80
    v_mov_b32 v218, 0x3f803f80
    v_mov_b32 v219, 0x3f803f80
    v_mov_b32 v220, 0x3f803f80
    v_mov_b32 v221, 0x3f803f80
    v_mov_b32 v222, 0x3f803f80
    v_mov_b32 v223, 0x3f803f80
    s_mov_b32 exec_lo, 0xe0000000
    s_mov_b32 exec_hi, 0xe0000000
    v_mov_b32 v216, 0
    v_mov_b32 v217, 0
    v_mov_b32 v218, 0
    v_mov_b32 v219, 0
    v_mov_b32 v220, 0
    v_mov_b32 v221, 0
    v_mov_b32 v222, 0
    v_mov_b32 v223, 0
    s_mov_b64 exec, -1
    buffer_store_dwordx4 v[216:219], v1, s[20:23], s40 offen offset:2048 sc1
    buffer_store_dwordx4 v[220:223], v1, s[20:23], s40 offen offset:3072 sc1
    v_mul_f32 v16, 0x3e8b97f6, v16
    v_mul_f32 v17, 0x3e8b97f6, v17
    v_mul_f32 v18, 0x3e8b97f6, v18
    v_mul_f32 v19, 0x3e8b97f6, v19
    v_mul_f32 v20, 0x3e8b97f6, v20
    v_mul_f32 v21, 0x3e8b97f6, v21
    v_mul_f32 v22, 0x3e8b97f6, v22
    v_mul_f32 v23, 0x3e8b97f6, v23
    v_mul_f32 v24, 0x3e8b97f6, v24
    v_mul_f32 v25, 0x3e8b97f6, v25
    v_mul_f32 v26, 0x3e8b97f6, v26
    v_mul_f32 v27, 0x3e8b97f6, v27
    v_mul_f32 v28, 0x3e8b97f6, v28
    v_mul_f32 v29, 0x3e8b97f6, v29
    v_mul_f32 v30, 0x3e8b97f6, v30
    v_mul_f32 v31, 0x3e8b97f6, v31
    s_mov_b32 exec_lo, 0
    v_mov_b32 v28, 1.0
    v_mov_b32 v29, 0
    v_mov_b32 v30, 0
    v_mov_b32 v31, 0
    s_mov_b32 exec_lo, -1
    v_cvt_pk_bf16_f32 v208, v16, v17
    v_cvt_pk_bf16_f32 v209, v18, v19
    v_cvt_pk_bf16_f32 v210, v20, v21
    v_cvt_pk_bf16_f32 v211, v22, v23
    v_cvt_pk_bf16_f32 v212, v24, v25
    v_cvt_pk_bf16_f32 v213, v26, v27
    v_cvt_pk_bf16_f32 v214, v28, v29
    v_cvt_pk_bf16_f32 v215, v30, v31
    buffer_store_dwordx4 v[208:211], v6, s[20:23], s40 offen sc1
    buffer_store_dwordx4 v[212:215], v6, s[20:23], s40 offen offset:1024 sc1
    ds_write_b128 v8, v[216:219] offset:2048
    ds_write_b128 v8, v[220:223] offset:3072
    ds_write_b128 v7, v[208:211]
    ds_write_b128 v7, v[212:215] offset:1024
    s_waitcnt vmcnt(4)
    s_mov_b32 exec_hi, 0x00ffffff
    ds_write_b16 v13, v206
    s_mov_b32 exec_hi, -1
    s_waitcnt lgkmcnt(0)
    s_mov_b32 s12, s4
    s_mov_b32 s13, s5
    s_mov_b32 s14, 401408
    s_mov_b32 s15, 0x00020000
    s_mov_b32 s16, s6
    s_mov_b32 s17, s7
    s_mov_b32 s18, 401408
    s_mov_b32 s19, 0x00020000
    s_mov_b32 s52, s28
    s_mov_b32 s53, s29
    s_mov_b32 s54, 1835008
    s_mov_b32 s55, 0x00020000
    s_barrier
    ds_read_b64_tr_b16 v[64:65], v15 offset:0
    ds_read_b64_tr_b16 v[66:67], v15 offset:256
    ds_read_b64_tr_b16 v[68:69], v15 offset:512
    ds_read_b64_tr_b16 v[70:71], v15 offset:768
    ds_read_b64_tr_b16 v[72:73], v15 offset:1024
    ds_read_b64_tr_b16 v[74:75], v15 offset:1280
    ds_read_b64_tr_b16 v[76:77], v15 offset:1536
    ds_read_b64_tr_b16 v[78:79], v15 offset:1792
    ds_read_b64_tr_b16 v[80:81], v15 offset:4096
    ds_read_b64_tr_b16 v[82:83], v15 offset:4352
    s_waitcnt lgkmcnt(8)
    v_mfma_f32_32x32x16_bf16 v[48:63], v[64:67], v[88:91], v[48:63]
    ds_read_b64_tr_b16 v[84:85], v15 offset:4608
    ds_read_b64_tr_b16 v[86:87], v15 offset:4864
    s_waitcnt lgkmcnt(8)
    v_mfma_f32_32x32x16_bf16 v[48:63], v[68:71], v[92:95], v[48:63]
    ds_read_b64_tr_b16 v[64:65], v15 offset:5120
    ds_read_b64_tr_b16 v[66:67], v15 offset:5376
    s_waitcnt lgkmcnt(8)
    v_mfma_f32_32x32x16_bf16 v[48:63], v[72:75], v[96:99], v[48:63]
    ds_read_b64_tr_b16 v[68:69], v15 offset:5632
    ds_read_b64_tr_b16 v[70:71], v15 offset:5888
    s_waitcnt lgkmcnt(8)
    v_mfma_f32_32x32x16_bf16 v[48:63], v[76:79], v[100:103], v[48:63]
    ds_read_b64_tr_b16 v[72:73], v15 offset:8192
    ds_read_b64_tr_b16 v[74:75], v15 offset:8448
    s_waitcnt lgkmcnt(8)
    v_mfma_f32_32x32x16_bf16 v[48:63], v[80:83], v[104:107], v[48:63]
    ds_read_b64_tr_b16 v[76:77], v15 offset:8704
    ds_read_b64_tr_b16 v[78:79], v15 offset:8960
    s_waitcnt lgkmcnt(8)
    v_mfma_f32_32x32x16_bf16 v[48:63], v[84:87], v[108:111], v[48:63]
    s_waitcnt vmcnt(0)
    v_mov_b32 v9, 1
    s_lshl_b32 s42, s33, 2
    v_mov_b32 v11, s42
    s_mov_b64 exec, 1
    ds_add_rtn_u32 v10, v5, v9
    v_add_u32 v12, 159872, v11
    ds_read_b32 v9, v12
    s_waitcnt lgkmcnt(0)
    v_readfirstlane_b32 s41, v10
    v_add_u32 v9, 1, v9
    s_nop 0
    s_cmp_lg_u32 s41, 7
    s_cbranch_scc1 L_ka_nopub
    buffer_store_dword v9, v11, s[24:27], s3 offen sc1
L_ka_nopub:
    s_mov_b64 exec, -1
    ds_read_b64_tr_b16 v[80:81], v15 offset:9216
    ds_read_b64_tr_b16 v[82:83], v15 offset:9472
    s_waitcnt lgkmcnt(8)
    v_mfma_f32_32x32x16_bf16 v[48:63], v[64:67], v[112:115], v[48:63]
    v_mov_b32 v16, 0
    v_mov_b32 v17, 0
    v_mov_b32 v18, 0
    v_mov_b32 v19, 0
    ds_read_b64_tr_b16 v[84:85], v15 offset:9728
    ds_read_b64_tr_b16 v[86:87], v15 offset:9984
    s_waitcnt lgkmcnt(8)
    v_mfma_f32_32x32x16_bf16 v[48:63], v[68:71], v[116:119], v[48:63]
    v_mov_b32 v20, 0
    v_mov_b32 v21, 0
    v_mov_b32 v22, 0
    v_mov_b32 v23, 0
    ds_read_b64_tr_b16 v[64:65], v15 offset:12288
    ds_read_b64_tr_b16 v[66:67], v15 offset:12544
    s_waitcnt lgkmcnt(8)
    v_mfma_f32_32x32x16_bf16 v[48:63], v[72:75], v[120:123], v[48:63]
    v_mov_b32 v24, 0
    v_mov_b32 v25, 0
    v_mov_b32 v26, 0
    v_mov_b32 v27, 0
    ds_read_b64_tr_b16 v[68:69], v15 offset:12800
    ds_read_b64_tr_b16 v[70:71], v15 offset:13056
    s_waitcnt lgkmcnt(8)
    v_mfma_f32_32x32x16_bf16 v[48:63], v[76:79], v[124:127], v[48:63]
    v_mov_b32 v28, 0
    v_mov_b32 v29, 0
    v_mov_b32 v30, 0
    v_mov_b32 v31, 0
    ds_read_b64_tr_b16 v[72:73], v15 offset:13312
    ds_read_b64_tr_b16 v[74:75], v15 offset:13568
    s_waitcnt lgkmcnt(8)
    v_mfma_f32_32x32x16_bf16 v[48:63], v[80:83], v[128:131], v[48:63]
    v_mov_b32 v32, 0
    v_mov_b32 v33, 0
    v_mov_b32 v34, 0
    v_mov_b32 v35, 0
    ds_read_b64_tr_b16 v[76:77], v15 offset:13824
    ds_read_b64_tr_b16 v[78:79], v15 offset:14080
    s_waitcnt lgkmcnt(8)
    v_mfma_f32_32x32x16_bf16 v[48:63], v[84:87], v[132:135], v[48:63]
    v_mov_b32 v36, 0
    v_mov_b32 v37, 0
    v_mov_b32 v38, 0
    v_mov_b32 v39, 0
    ds_read_b64_tr_b16 v[80:81], v15 offset:16384
    ds_read_b64_tr_b16 v[82:83], v15 offset:16640
    s_waitcnt lgkmcnt(8)
    v_mfma_f32_32x32x16_bf16 v[48:63], v[64:67], v[136:139], v[48:63]
    v_mov_b32 v40, 0
    v_mov_b32 v41, 0
    v_mov_b32 v42, 0
    v_mov_b32 v43, 0
    ds_read_b64_tr_b16 v[84:85], v15 offset:16896
    ds_read_b64_tr_b16 v[86:87], v15 offset:17152
    s_waitcnt lgkmcnt(8)
    v_mfma_f32_32x32x16_bf16 v[48:63], v[68:71], v[140:143], v[48:63]
    v_mov_b32 v44, 0
    v_mov_b32 v45, 0
    v_mov_b32 v46, 0
    v_mov_b32 v47, 0
    ds_read_b64_tr_b16 v[64:65], v15 offset:17408
    ds_read_b64_tr_b16 v[66:67], v15 offset:17664
    s_waitcnt lgkmcnt(8)
    v_mfma_f32_32x32x16_bf16 v[48:63], v[72:75], v[144:147], v[48:63]
    ds_read_b64_tr_b16 v[68:69], v15 offset:17920
    ds_read_b64_tr_b16 v[70:71], v15 offset:18176
    s_waitcnt lgkmcnt(8)
    v_mfma_f32_32x32x16_bf16 v[48:63], v[76:79], v[148:151], v[48:63]
    ds_read_b64_tr_b16 v[72:73], v15 offset:20480
    ds_read_b64_tr_b16 v[74:75], v15 offset:20736
    s_waitcnt lgkmcnt(8)
    v_mfma_f32_32x32x16_bf16 v[48:63], v[80:83], v[152:155], v[48:63]
    ds_read_b64_tr_b16 v[76:77], v15 offset:20992
    ds_read_b64_tr_b16 v[78:79], v15 offset:21248
    s_waitcnt lgkmcnt(8)
    v_mfma_f32_32x32x16_bf16 v[48:63], v[84:87], v[156:159], v[48:63]
    v_lshrrev_b32 v236, 2, v2
    v_mul_u32_u24 v236, 896, v236
    v_and_b32 v237, 3, v2
    v_lshl_add_u32 v236, v237, 4, v236
    v_add_u32 v237, 64, v236
    ds_read_b64_tr_b16 v[80:81], v15 offset:21504
    ds_read_b64_tr_b16 v[82:83], v15 offset:21760
    s_waitcnt lgkmcnt(8)
    v_mfma_f32_32x32x16_bf16 v[48:63], v[64:67], v[160:163], v[48:63]
    ds_read_b64_tr_b16 v[84:85], v15 offset:22016
    ds_read_b64_tr_b16 v[86:87], v15 offset:22272
    s_waitcnt lgkmcnt(8)
    v_mfma_f32_32x32x16_bf16 v[48:63], v[68:71], v[164:167], v[48:63]
    ds_read_b64_tr_b16 v[64:65], v15 offset:24576
    ds_read_b64_tr_b16 v[66:67], v15 offset:24832
    s_waitcnt lgkmcnt(8)
    v_mfma_f32_32x32x16_bf16 v[48:63], v[72:75], v[168:171], v[48:63]
    ds_read_b64_tr_b16 v[68:69], v15 offset:25088
    ds_read_b64_tr_b16 v[70:71], v15 offset:25344
    s_waitcnt lgkmcnt(8)
    v_mfma_f32_32x32x16_bf16 v[48:63], v[76:79], v[172:175], v[48:63]
    ds_read_b64_tr_b16 v[72:73], v15 offset:25600
    ds_read_b64_tr_b16 v[74:75], v15 offset:25856
    s_waitcnt lgkmcnt(8)
    v_mfma_f32_32x32x16_bf16 v[48:63], v[80:83], v[176:179], v[48:63]
    ds_read_b64_tr_b16 v[76:77], v15 offset:26112
    ds_read_b64_tr_b16 v[78:79], v15 offset:26368
    s_waitcnt lgkmcnt(8)
    v_mfma_f32_32x32x16_bf16 v[48:63], v[84:87], v[180:183], v[48:63]
    s_waitcnt lgkmcnt(6)
    v_mfma_f32_32x32x16_bf16 v[48:63], v[64:67], v[184:187], v[48:63]
    s_waitcnt lgkmcnt(4)
    v_mfma_f32_32x32x16_bf16 v[48:63], v[68:71], v[188:191], v[48:63]
    s_xor_b32 s50, s49, 16384
    v_add_u32 v7, s50, v1
    s_lshl_b32 s50, s43, 14
    v_add_u32 v10, s50, v1
    v_mov_b32 v6, v10
    v_mov_b32 v5, 0xdddd
    s_waitcnt lgkmcnt(2)
    v_mfma_f32_32x32x16_bf16 v[48:63], v[72:75], v[192:195], v[48:63]
    v_mov_b32 v220, 0
    v_mov_b32 v221, 0
    v_mov_b32 v222, 0
    v_mov_b32 v223, 0
    s_mov_b32 s46, 0
    s_mov_b32 s60, 1
    s_mov_b32 s62, 0xff
    s_bitset0_b32 s62, s33
    s_mov_b32 s50, 0x3e8b97f6
    s_mov_b32 s51, 0xbfb8aa3b
    s_cmp_lg_u32 s35, s65
    s_cbranch_scc1 L_ka_nopoll
    buffer_load_dword v227, v225, s[24:27], s3 offen sc1
L_ka_nopoll:
    s_waitcnt lgkmcnt(0)
    v_mfma_f32_32x32x16_bf16 v[48:63], v[76:79], v[196:199], v[48:63]
    ds_read_b128 v[176:179], v6 offset:0
    ds_read_b128 v[180:183], v6 offset:1024
    ds_read_b128 v[192:195], v6 offset:2048
    ds_read_b128 v[196:199], v6 offset:3072
    ds_read_b128 v[184:187], v6 offset:4096
    ds_read_b128 v[188:191], v6 offset:5120
    ds_read_b128 v[200:203], v6 offset:6144
    ds_read_b128 v[204:207], v6 offset:7168
    v_mov_b32 v168, 0
    v_mov_b32 v169, 0
    v_mov_b32 v170, 0
    v_mov_b32 v171, 0
    v_mov_b32 v172, 0
    v_mov_b32 v173, 0
    v_mov_b32 v174, 0
    v_mov_b32 v175, 0
    v_mul_f32 v12, s51, v60
    v_exp_f32 v12, v12
    v_cvt_pk_bf16_f32 v72, v48, v49
    v_cvt_pk_bf16_f32 v73, v50, v51
    v_cvt_pk_bf16_f32 v74, v52, v53
    v_cvt_pk_bf16_f32 v75, v54, v55
    v_cvt_pk_bf16_f32 v76, v56, v57
    v_cvt_pk_bf16_f32 v77, v58, v59
    v_cvt_pk_bf16_f32 v78, v60, v61
    v_cvt_pk_bf16_f32 v79, v62, v63
    s_mov_b32 exec_lo, 0
    v_mov_b32 v78, 0
    v_mov_b32 v79, 0
    s_mov_b32 exec_lo, -1
    s_waitcnt lgkmcnt(6)
    v_mfma_f32_32x32x16_bf16 v[128:143], v[176:179], v[72:75], 0
    v_mfma_f32_32x32x16_bf16 v[128:143], v[180:183], v[76:79], v[128:143]
    ds_write_b128 v8, v[72:75] offset:32768
    v_add_f32 v12, 1.0, v12
    v_rcp_f32 v12, v12
    s_cmp_lg_u32 s35, s65
    s_cbranch_scc1 L_ka_nofw
    s_waitcnt vmcnt(0)
    v_cmp_ne_u32 vcc, v227, v224
    v_mov_b32 v11, 159808
    s_nop 4
    s_and_b32 s46, vcc_lo, 0xff
    v_mov_b32 v9, s46
    ds_write_b32 v11, v9
L_ka_nofw:
    v_mul_f32 v12, s47, v12
    v_add_f32 v12, s48, v12
    v_mov_b32 v13, v12
    s_nop 1
    v_permlane32_swap_b32 v12, v13
    s_nop 3
    v_max3_f32 v48, v128, v129, v130
    v_max3_f32 v49, v131, v132, v133
    v_max3_f32 v50, v134, v135, v136
    v_max3_f32 v51, v137, v138, v139
    v_max3_f32 v52, v140, v141, v142
    v_max3_f32 v48, v48, v49, v143
    v_max3_f32 v50, v50, v51, v52
    v_max_f32 v48, v48, v50
    v_mov_b32 v49, v48
    s_nop 1
    v_permlane32_swap_b32 v48, v49
    s_nop 1
    v_max_f32 v48, v48, v49
    v_ashrrev_i32 v49, 31, v48
    v_and_b32 v49, 0xffff, v49
    v_add_u32 v48, v48, v49
    v_lshrrev_b32 v48, 16, v48
    s_mov_b32 exec_lo, 0
    v_xor_b32 v78, 0x8000, v48
    s_mov_b32 exec_lo, -1
    ds_write_b128 v8, v[76:79] offset:33792
    s_nop 0
    v_mfma_f32_32x32x16_bf16 v[128:143], v[176:179], v[72:75], 0
    v_mfma_f32_32x32x16_bf16 v[128:143], v[180:183], v[76:79], v[128:143]
    s_waitcnt lgkmcnt(0)
    s_barrier
    ds_read_b128 v[64:67], v7 offset:32768
    ds_read_b128 v[68:71], v7 offset:33792
    s_and_b32 s40, s46, s62
    s_cbranch_scc1 L_ka_fl1045_ok
    s_mov_b32 s61, 0
    v_mov_b32 v8, 159808
L_ka_fl1045_spin:
    s_cmp_lg_u32 s35, s65
    s_cbranch_scc1 L_ka_fl1045_lds
    buffer_load_dword v11, v225, s[24:27], s3 offen sc1
    v_mov_b32 v9, 0
    s_and_b32 s41, s61, 7
    s_cmp_lg_u32 s41, 7
    s_cbranch_scc1 L_ka_fl1045_nodbg
    buffer_load_dword v9, v9, s[56:59], s63 offen sc1
L_ka_fl1045_nodbg:
    s_waitcnt vmcnt(0)
    v_cmp_ne_u32 vcc, v11, v224
    s_nop 4
    s_or_b32 s41, vcc_lo, s46
    v_or_b32 v11, s41, v9
    v_and_b32 v11, 0xff, v11
    ds_write_b32 v8, v11
    s_add_u32 s61, s61, 16
    s_branch L_ka_fl1045_chk
L_ka_fl1045_lds:
    ds_read_b32 v11, v8
    s_waitcnt lgkmcnt(0)
L_ka_fl1045_chk:
    v_readfirstlane_b32 s46, v11
    s_add_u32 s61, s61, 1
    s_mov_b32 s40, s62
    s_cmp_ge_u32 s61, 0x1000000
    s_cbranch_scc1 L_ka_fl1045_ok
    s_and_b32 s40, s46, s62
    s_cbranch_scc1 L_ka_fl1045_ok
    s_sleep 1
    s_branch L_ka_fl1045_spin
L_ka_fl1045_ok:
    s_lshl_b32 s41, s40, 8
    s_or_b32 s40, s40, s41
    s_lshr_b32 s40, s40, s33
    s_ff1_i32_b32 s40, s40
    s_add_u32 s40, s40, s33
    s_and_b32 s40, s40, 7
    s_bitset0_b32 s62, s40
    s_lshl_b32 s40, s40, 15
    s_add_u32 s40, s40, s49
    s_lshl_b32 s41, s60, 2
    s_lshr_b32 s41, 0x13201320, s41
    s_and_b32 s41, s41, 15
    s_lshl_b32 s41, s41, 15
    s_add_u32 m0, s41, s49
    s_add_u32 s60, s60, 1
    buffer_load_dwordx4 v1, s[20:23], s40 offen offset:0 sc1 lds
    buffer_load_dwordx4 v1, s[20:23], s40 offen offset:1024 sc1 lds
    buffer_load_dwordx4 v1, s[20:23], s40 offen offset:2048 sc1 lds
    buffer_load_dwordx4 v1, s[20:23], s40 offen offset:3072 sc1 lds
    s_waitcnt lgkmcnt(0)
    v_mfma_f32_32x32x16_bf16 v[112:127], v[176:179], v[64:67], 0
    v_mfma_f32_32x32x16_bf16 v[112:127], v[180:183], v[68:71], v[112:127]
    s_nop 7
    s_nop 1
    s_mov_b32 s45, 0
    .p2align 3
    s_setprio 1
    s_waitcnt lgkmcnt(0)
    v_exp_f32 v112, v112
    v_exp_f32 v113, v113
    v_smfmac_f32_32x32x32_bf16 v[32:47], v[220:223], v[168:175], v5
    ds_read_b128 v[176:179], v6 offset:8192
    ds_read_b128 v[180:183], v6 offset:9216
    v_exp_f32 v114, v114
    v_exp_f32 v115, v115
    v_exp_f32 v116, v116
    v_exp_f32 v117, v117
    v_mfma_f32_32x32x16_bf16 v[144:159], v[184:187], v[64:67], 0
    ds_read_b128 v[208:211], v6 offset:10240
    ds_read_b128 v[212:215], v6 offset:11264
    v_exp_f32 v118, v118
    v_exp_f32 v119, v119
    v_exp_f32 v120, v120
    v_exp_f32 v121, v121
    v_mfma_f32_32x32x16_bf16 v[144:159], v[188:191], v[68:71], v[144:159]
    v_exp_f32 v122, v122
    v_exp_f32 v123, v123
    v_exp_f32 v124, v124
    v_exp_f32 v125, v125
    v_smfmac_f32_32x32x32_bf16 v[16:31], v[192:195], v[112:119], v5
    v_exp_f32 v126, v126
    v_exp_f32 v127, v127
    s_and_b32 s40, s46, s62
    s_cbranch_scc1 L_ka_fl1134_ok
    s_mov_b32 s61, 0
    v_mov_b32 v8, 159808
L_ka_fl1134_spin:
    s_cmp_lg_u32 s35, s65
    s_cbranch_scc1 L_ka_fl1134_lds
    buffer_load_dword v11, v225, s[24:27], s3 offen sc1
    v_mov_b32 v9, 0
    s_and_b32 s41, s61, 7
    s_cmp_lg_u32 s41, 7
    s_cbranch_scc1 L_ka_fl1134_nodbg
    buffer_load_dword v9, v9, s[56:59], s63 offen sc1
L_ka_fl1134_nodbg:
    s_waitcnt vmcnt(0)
    v_cmp_ne_u32 vcc, v11, v224
    s_nop 4
    s_or_b32 s41, vcc_lo, s46
    v_or_b32 v11, s41, v9
    v_and_b32 v11, 0xff, v11
    ds_write_b32 v8, v11
    s_add_u32 s61, s61, 16
    s_branch L_ka_fl1134_chk
L_ka_fl1134_lds:
    ds_read_b32 v11, v8
    s_waitcnt lgkmcnt(0)
L_ka_fl1134_chk:
    v_readfirstlane_b32 s46, v11
    s_add_u32 s61, s61, 1
    s_mov_b32 s40, s62
    s_cmp_ge_u32 s61, 0x1000000
    s_cbranch_scc1 L_ka_fl1134_ok
    s_and_b32 s40, s46, s62
    s_cbranch_scc1 L_ka_fl1134_ok
    s_sleep 1
    s_branch L_ka_fl1134_spin
L_ka_fl1134_ok:
    s_lshl_b32 s41, s40, 8
    s_or_b32 s40, s40, s41
    s_lshr_b32 s40, s40, s33
    s_ff1_i32_b32 s40, s40
    s_add_u32 s40, s40, s33
    s_and_b32 s40, s40, 7
    s_bitset0_b32 s62, s40
    s_lshl_b32 s40, s40, 15
    s_add_u32 s40, s40, s49
    s_lshl_b32 s41, s60, 2
    s_lshr_b32 s41, 0x13201320, s41
    s_and_b32 s41, s41, 15
    s_lshl_b32 s41, s41, 15
    s_add_u32 m0, s41, s49
    s_add_u32 s60, s60, 1
    buffer_load_dwordx4 v1, s[20:23], s40 offen offset:0 sc1 lds
    buffer_load_dwordx4 v1, s[20:23], s40 offen offset:1024 sc1 lds
    buffer_load_dwordx4 v1, s[20:23], s40 offen offset:2048 sc1 lds
    buffer_load_dwordx4 v1, s[20:23], s40 offen offset:3072 sc1 lds
    .p2align 3
    v_exp_f32 v128, v128
    v_exp_f32 v129, v129
    v_smfmac_f32_32x32x32_bf16 v[16:31], v[196:199], v[120:127], v5
    v_exp_f32 v130, v130
    v_exp_f32 v131, v131
    v_exp_f32 v132, v132
    v_exp_f32 v133, v133
    v_mfma_f32_32x32x16_bf16 v[160:175], v[184:187], v[72:75], 0
    v_exp_f32 v134, v134
    v_exp_f32 v135, v135
    v_exp_f32 v136, v136
    v_exp_f32 v137, v137
    v_mfma_f32_32x32x16_bf16 v[160:175], v[188:191], v[76:79], v[160:175]
    v_exp_f32 v138, v138
    v_exp_f32 v139, v139
    v_exp_f32 v140, v140
    v_exp_f32 v141, v141
    v_smfmac_f32_32x32x32_bf16 v[32:47], v[192:195], v[128:135], v5
    v_exp_f32 v142, v142
    v_exp_f32 v143, v143
    .p2align 3
    s_setprio 0
    s_waitcnt lgkmcnt(0)
    v_exp_f32 v144, v144
    v_exp_f32 v145, v145
    v_smfmac_f32_32x32x32_bf16 v[32:47], v[196:199], v[136:143], v5
    ds_read_b128 v[184:187], v6 offset:12288
    ds_read_b128 v[188:191], v6 offset:13312
    v_exp_f32 v146, v146
    v_exp_f32 v147, v147
    v_exp_f32 v148, v148
    v_exp_f32 v149, v149
    v_mfma_f32_32x32x16_bf16 v[112:127], v[176:179], v[64:67], 0
    ds_read_b128 v[216:219], v6 offset:14336
    ds_read_b128 v[220:223], v6 offset:15360
    v_exp_f32 v150, v150
    v_exp_f32 v151, v151
    v_exp_f32 v152, v152
    v_exp_f32 v153, v153
    v_mfma_f32_32x32x16_bf16 v[112:127], v[180:183], v[68:71], v[112:127]
    v_exp_f32 v154, v154
    v_exp_f32 v155, v155
    v_exp_f32 v156, v156
    v_exp_f32 v157, v157
    v_smfmac_f32_32x32x32_bf16 v[16:31], v[200:203], v[144:151], v5
    v_exp_f32 v158, v158
    v_exp_f32 v159, v159
    s_lshl_b32 s41, s45, 2
    s_lshr_b32 s41, 0x01320132, s41
    s_and_b32 s41, s41, 15
    s_lshl_b32 s41, s41, 15
    v_add_u32 v6, s41, v10
    s_add_u32 s45, s45, 1
    s_nop 0
    .p2align 3
    v_exp_f32 v160, v160
    v_exp_f32 v161, v161
    v_smfmac_f32_32x32x32_bf16 v[16:31], v[204:207], v[152:159], v5
    v_exp_f32 v162, v162
    v_exp_f32 v163, v163
    v_exp_f32 v164, v164
    v_exp_f32 v165, v165
    v_mfma_f32_32x32x16_bf16 v[128:143], v[176:179], v[72:75], 0
    v_exp_f32 v166, v166
    v_exp_f32 v167, v167
    v_exp_f32 v168, v168
    v_exp_f32 v169, v169
    v_mfma_f32_32x32x16_bf16 v[128:143], v[180:183], v[76:79], v[128:143]
    v_exp_f32 v170, v170
    v_exp_f32 v171, v171
    v_exp_f32 v172, v172
    v_exp_f32 v173, v173
    v_smfmac_f32_32x32x32_bf16 v[32:47], v[200:203], v[160:167], v5
    v_exp_f32 v174, v174
    v_exp_f32 v175, v175
    .p2align 6
L_ka_loop:
    s_cmp_ge_u32 s45, 7
    s_cbranch_scc1 L_ka_w0
    s_waitcnt vmcnt(4)
    s_barrier
L_ka_w1:
    .p2align 3
    s_setprio 3
    s_waitcnt lgkmcnt(0)
    v_exp_f32 v112, v112
    v_exp_f32 v113, v113
    v_smfmac_f32_32x32x32_bf16 v[32:47], v[204:207], v[168:175], v5
    ds_read_b128 v[176:179], v6 offset:0
    ds_read_b128 v[180:183], v6 offset:1024
    v_exp_f32 v114, v114
    v_exp_f32 v115, v115
    v_exp_f32 v116, v116
    v_exp_f32 v117, v117
    v_mfma_f32_32x32x16_bf16 v[144:159], v[184:187], v[64:67], 0
    ds_read_b128 v[192:195], v6 offset:2048
    ds_read_b128 v[196:199], v6 offset:3072
    v_exp_f32 v118, v118
    v_exp_f32 v119, v119
    v_exp_f32 v120, v120
    v_exp_f32 v121, v121
    v_mfma_f32_32x32x16_bf16 v[144:159], v[188:191], v[68:71], v[144:159]
    v_exp_f32 v122, v122
    v_exp_f32 v123, v123
    v_exp_f32 v124, v124
    v_exp_f32 v125, v125
    v_smfmac_f32_32x32x32_bf16 v[16:31], v[208:211], v[112:119], v5
    v_exp_f32 v126, v126
    v_exp_f32 v127, v127
    s_cmp_eq_u32 s43, 0
    s_cbranch_scc1 L_ka_sidein
L_ka_ret0:
    .p2align 3
    v_exp_f32 v128, v128
    v_exp_f32 v129, v129
    v_smfmac_f32_32x32x32_bf16 v[16:31], v[212:215], v[120:127], v5
    v_exp_f32 v130, v130
    v_exp_f32 v131, v131
    v_exp_f32 v132, v132
    v_exp_f32 v133, v133
    v_mfma_f32_32x32x16_bf16 v[160:175], v[184:187], v[72:75], 0
    v_exp_f32 v134, v134
    v_exp_f32 v135, v135
    v_exp_f32 v136, v136
    v_exp_f32 v137, v137
    v_mfma_f32_32x32x16_bf16 v[160:175], v[188:191], v[76:79], v[160:175]
    v_exp_f32 v138, v138
    v_exp_f32 v139, v139
    v_exp_f32 v140, v140
    v_exp_f32 v141, v141
    v_smfmac_f32_32x32x32_bf16 v[32:47], v[208:211], v[128:135], v5
    v_exp_f32 v142, v142
    v_exp_f32 v143, v143
    .p2align 3
    s_setprio 2
    s_waitcnt lgkmcnt(0)
    v_exp_f32 v144, v144
    v_exp_f32 v145, v145
    v_smfmac_f32_32x32x32_bf16 v[32:47], v[212:215], v[136:143], v5
    ds_read_b128 v[184:187], v6 offset:4096
    ds_read_b128 v[188:191], v6 offset:5120
    v_exp_f32 v146, v146
    v_exp_f32 v147, v147
    v_exp_f32 v148, v148
    v_exp_f32 v149, v149
    v_mfma_f32_32x32x16_bf16 v[112:127], v[176:179], v[64:67], 0
    ds_read_b128 v[200:203], v6 offset:6144
    ds_read_b128 v[204:207], v6 offset:7168
    v_exp_f32 v150, v150
    v_exp_f32 v151, v151
    v_exp_f32 v152, v152
    v_exp_f32 v153, v153
    v_mfma_f32_32x32x16_bf16 v[112:127], v[180:183], v[68:71], v[112:127]
    v_exp_f32 v154, v154
    v_exp_f32 v155, v155
    v_exp_f32 v156, v156
    v_exp_f32 v157, v157
    v_smfmac_f32_32x32x32_bf16 v[16:31], v[216:219], v[144:151], v5
    v_exp_f32 v158, v158
    v_exp_f32 v159, v159
    s_cmp_eq_u32 s43, 1
    s_cbranch_scc1 L_ka_sidein
L_ka_ret1:
    .p2align 3
    v_exp_f32 v160, v160
    v_exp_f32 v161, v161
    v_smfmac_f32_32x32x32_bf16 v[16:31], v[220:223], v[152:159], v5
    v_exp_f32 v162, v162
    v_exp_f32 v163, v163
    v_exp_f32 v164, v164
    v_exp_f32 v165, v165
    v_mfma_f32_32x32x16_bf16 v[128:143], v[176:179], v[72:75], 0
    v_exp_f32 v166, v166
    v_exp_f32 v167, v167
    v_exp_f32 v168, v168
    v_exp_f32 v169, v169
    v_mfma_f32_32x32x16_bf16 v[128:143], v[180:183], v[76:79], v[128:143]
    v_exp_f32 v170, v170
    v_exp_f32 v171, v171
    v_exp_f32 v172, v172
    v_exp_f32 v173, v173
    v_smfmac_f32_32x32x32_bf16 v[32:47], v[216:219], v[160:167], v5
    v_exp_f32 v174, v174
    v_exp_f32 v175, v175
    .p2align 3
    s_setprio 1
    s_waitcnt lgkmcnt(0)
    v_exp_f32 v112, v112
    v_exp_f32 v113, v113
    v_smfmac_f32_32x32x32_bf16 v[32:47], v[220:223], v[168:175], v5
    ds_read_b128 v[176:179], v6 offset:8192
    ds_read_b128 v[180:183], v6 offset:9216
    v_exp_f32 v114, v114
    v_exp_f32 v115, v115
    v_exp_f32 v116, v116
    v_exp_f32 v117, v117
    v_mfma_f32_32x32x16_bf16 v[144:159], v[184:187], v[64:67], 0
    ds_read_b128 v[208:211], v6 offset:10240
    ds_read_b128 v[212:215], v6 offset:11264
    v_exp_f32 v118, v118
    v_exp_f32 v119, v119
    v_exp_f32 v120, v120
    v_exp_f32 v121, v121
    v_mfma_f32_32x32x16_bf16 v[144:159], v[188:191], v[68:71], v[144:159]
    v_exp_f32 v122, v122
    v_exp_f32 v123, v123
    v_exp_f32 v124, v124
    v_exp_f32 v125, v125
    v_smfmac_f32_32x32x32_bf16 v[16:31], v[192:195], v[112:119], v5
    v_exp_f32 v126, v126
    v_exp_f32 v127, v127
    v_exp_f32 v128, v128
    v_exp_f32 v129, v129
    v_smfmac_f32_32x32x32_bf16 v[16:31], v[196:199], v[120:127], v5
    v_exp_f32 v130, v130
    v_exp_f32 v131, v131
    v_exp_f32 v132, v132
    v_exp_f32 v133, v133
    v_mfma_f32_32x32x16_bf16 v[160:175], v[184:187], v[72:75], 0
    v_exp_f32 v134, v134
    v_exp_f32 v135, v135
    v_exp_f32 v136, v136
    v_exp_f32 v137, v137
    v_mfma_f32_32x32x16_bf16 v[160:175], v[188:191], v[76:79], v[160:175]
    v_exp_f32 v138, v138
    v_exp_f32 v139, v139
    v_exp_f32 v140, v140
    v_exp_f32 v141, v141
    v_smfmac_f32_32x32x32_bf16 v[32:47], v[192:195], v[128:135], v5
    v_exp_f32 v142, v142
    v_exp_f32 v143, v143
    .p2align 3
    s_setprio 0
    s_waitcnt lgkmcnt(0)
    v_exp_f32 v144, v144
    v_exp_f32 v145, v145
    v_smfmac_f32_32x32x32_bf16 v[32:47], v[196:199], v[136:143], v5
    ds_read_b128 v[184:187], v6 offset:12288
    ds_read_b128 v[188:191], v6 offset:13312
    v_exp_f32 v146, v146
    v_exp_f32 v147, v147
    v_exp_f32 v148, v148
    v_exp_f32 v149, v149
    v_mfma_f32_32x32x16_bf16 v[112:127], v[176:179], v[64:67], 0
    ds_read_b128 v[216:219], v6 offset:14336
    ds_read_b128 v[220:223], v6 offset:15360
    v_exp_f32 v150, v150
    v_exp_f32 v151, v151
    v_exp_f32 v152, v152
    v_exp_f32 v153, v153
    v_mfma_f32_32x32x16_bf16 v[112:127], v[180:183], v[68:71], v[112:127]
    v_exp_f32 v154, v154
    v_exp_f32 v155, v155
    v_exp_f32 v156, v156
    v_exp_f32 v157, v157
    v_smfmac_f32_32x32x32_bf16 v[16:31], v[200:203], v[144:151], v5
    v_exp_f32 v158, v158
    v_exp_f32 v159, v159
    s_lshl_b32 s41, s45, 2
    s_lshr_b32 s41, 0x01320132, s41
    s_and_b32 s41, s41, 15
    s_lshl_b32 s41, s41, 15
    v_add_u32 v6, s41, v10
    s_add_u32 s45, s45, 1
    s_nop 0
    .p2align 3
    v_exp_f32 v160, v160
    v_exp_f32 v161, v161
    v_smfmac_f32_32x32x32_bf16 v[16:31], v[204:207], v[152:159], v5
    v_exp_f32 v162, v162
    v_exp_f32 v163, v163
    v_exp_f32 v164, v164
    v_exp_f32 v165, v165
    v_mfma_f32_32x32x16_bf16 v[128:143], v[176:179], v[72:75], 0
    v_exp_f32 v166, v166
    v_exp_f32 v167, v167
    v_exp_f32 v168, v168
    v_exp_f32 v169, v169
    v_mfma_f32_32x32x16_bf16 v[128:143], v[180:183], v[76:79], v[128:143]
    v_exp_f32 v170, v170
    v_exp_f32 v171, v171
    v_exp_f32 v172, v172
    v_exp_f32 v173, v173
    v_smfmac_f32_32x32x32_bf16 v[32:47], v[200:203], v[160:167], v5
    v_exp_f32 v174, v174
    v_exp_f32 v175, v175
    s_cmp_lt_u32 s45, 8
    s_cbranch_scc1 L_ka_loop
    .p2align 3
    s_setprio 1
    s_waitcnt lgkmcnt(0)
    v_exp_f32 v112, v112
    v_exp_f32 v113, v113
    v_smfmac_f32_32x32x32_bf16 v[32:47], v[204:207], v[168:175], v5
    v_exp_f32 v114, v114
    v_exp_f32 v115, v115
    v_exp_f32 v116, v116
    v_exp_f32 v117, v117
    v_mfma_f32_32x32x16_bf16 v[144:159], v[184:187], v[64:67], 0
    v_exp_f32 v118, v118
    v_exp_f32 v119, v119
    v_exp_f32 v120, v120
    v_exp_f32 v121, v121
    v_mfma_f32_32x32x16_bf16 v[144:159], v[188:191], v[68:71], v[144:159]
    v_exp_f32 v122, v122
    v_exp_f32 v123, v123
    v_exp_f32 v124, v124
    v_exp_f32 v125, v125
    v_smfmac_f32_32x32x32_bf16 v[16:31], v[208:211], v[112:119], v5
    v_exp_f32 v126, v126
    v_exp_f32 v127, v127
    s_add_u32 s40, s49, 98304
    v_add_u32 v8, s40, v1
    s_xor_b32 s40, s40, 16384
    v_add_u32 v9, s40, v1
    s_mov_b32 s66, 0
    .p2align 3
    v_exp_f32 v128, v128
    v_exp_f32 v129, v129
    v_smfmac_f32_32x32x32_bf16 v[16:31], v[212:215], v[120:127], v5
    v_exp_f32 v130, v130
    v_exp_f32 v131, v131
    v_exp_f32 v132, v132
    v_exp_f32 v133, v133
    v_mfma_f32_32x32x16_bf16 v[160:175], v[184:187], v[72:75], 0
    v_exp_f32 v134, v134
    v_exp_f32 v135, v135
    v_exp_f32 v136, v136
    v_exp_f32 v137, v137
    v_mfma_f32_32x32x16_bf16 v[160:175], v[188:191], v[76:79], v[160:175]
    v_exp_f32 v138, v138
    v_exp_f32 v139, v139
    v_exp_f32 v140, v140
    v_exp_f32 v141, v141
    v_smfmac_f32_32x32x32_bf16 v[32:47], v[208:211], v[128:135], v5
    v_exp_f32 v142, v142
    v_exp_f32 v143, v143
    .p2align 3
    s_setprio 0
    s_waitcnt lgkmcnt(0)
    v_exp_f32 v144, v144
    v_exp_f32 v145, v145
    v_smfmac_f32_32x32x32_bf16 v[32:47], v[212:215], v[136:143], v5
    v_exp_f32 v146, v146
    v_exp_f32 v147, v147
    v_exp_f32 v148, v148
    v_exp_f32 v149, v149
    v_exp_f32 v150, v150
    v_exp_f32 v151, v151
    v_exp_f32 v152, v152
    v_exp_f32 v153, v153
    v_exp_f32 v154, v154
    v_exp_f32 v155, v155
    v_exp_f32 v156, v156
    v_exp_f32 v157, v157
    v_smfmac_f32_32x32x32_bf16 v[16:31], v[216:219], v[144:151], v5
    v_exp_f32 v158, v158
    v_exp_f32 v159, v159
    v_exp_f32 v160, v160
    v_exp_f32 v161, v161
    v_smfmac_f32_32x32x32_bf16 v[16:31], v[220:223], v[152:159], v5
    v_exp_f32 v162, v162
    v_exp_f32 v163, v163
    v_exp_f32 v164, v164
    v_exp_f32 v165, v165
    v_exp_f32 v166, v166
    v_exp_f32 v167, v167
    v_exp_f32 v168, v168
    v_exp_f32 v169, v169
    v_exp_f32 v170, v170
    v_exp_f32 v171, v171
    v_exp_f32 v172, v172
    v_exp_f32 v173, v173
    v_smfmac_f32_32x32x32_bf16 v[32:47], v[216:219], v[160:167], v5
    v_exp_f32 v174, v174
    v_exp_f32 v175, v175
    ds_write_b128 v8, v[16:19] offset:0
    ds_write_b128 v8, v[20:23] offset:1024
    ds_write_b128 v8, v[24:27] offset:2048
    ds_write_b128 v8, v[28:31] offset:3072
    v_smfmac_f32_32x32x32_bf16 v[32:47], v[220:223], v[168:175], v5
    s_waitcnt lgkmcnt(0)
    s_barrier
    ds_read_b128 v[28:31], v9 offset:3072
    ds_read_b128 v[16:19], v9 offset:0
    ds_read_b128 v[20:23], v9 offset:1024
    ds_read_b128 v[24:27], v9 offset:2048
    v_mov_b32 v235, 159744
    ds_read_b32 v235, v235 offset:68
    s_nop 4
    s_waitcnt lgkmcnt(4)
L_ka_fin:
    v_add_f32 v51, v44, v28
    v_mov_b32 v52, v51
    s_nop 1
    v_permlane32_swap_b32 v51, v52
    s_nop 1
    v_rcp_f32 v52, v52
    s_waitcnt lgkmcnt(0)
    v_pk_add_f32 v[128:129], v[32:33], v[16:17]
    v_pk_add_f32 v[130:131], v[34:35], v[18:19]
    v_pk_add_f32 v[132:133], v[36:37], v[20:21]
    v_pk_add_f32 v[134:135], v[38:39], v[22:23]
    v_mul_f32 v52, v52, v13
    v_pk_add_f32 v[136:137], v[40:41], v[24:25]
    v_pk_add_f32 v[138:139], v[42:43], v[26:27]
    v_pk_add_f32 v[140:141], v[44:45], v[28:29]
    v_pk_add_f32 v[142:143], v[46:47], v[30:31]
    v_pk_mul_f32 v[128:129], v[128:129], v[52:53] op_sel_hi:[1,0]
    v_pk_mul_f32 v[130:131], v[130:131], v[52:53] op_sel_hi:[1,0]
    v_pk_mul_f32 v[132:133], v[132:133], v[52:53] op_sel_hi:[1,0]
    v_pk_mul_f32 v[134:135], v[134:135], v[52:53] op_sel_hi:[1,0]
    v_cvt_pk_bf16_f32 v112, v128, v129
    v_cvt_pk_bf16_f32 v113, v130, v131
    v_cvt_pk_bf16_f32 v114, v132, v133
    v_cvt_pk_bf16_f32 v115, v134, v135
    buffer_store_dwordx4 v[112:115], v1, s[24:27], s64 offen offset:0 sc1
    v_pk_mul_f32 v[136:137], v[136:137], v[52:53] op_sel_hi:[1,0]
    v_pk_mul_f32 v[138:139], v[138:139], v[52:53] op_sel_hi:[1,0]
    v_pk_mul_f32 v[140:141], v[140:141], v[52:53] op_sel_hi:[1,0]
    v_pk_mul_f32 v[142:143], v[142:143], v[52:53] op_sel_hi:[1,0]
    v_cvt_pk_bf16_f32 v116, v136, v137
    v_cvt_pk_bf16_f32 v117, v138, v139
    v_cvt_pk_bf16_f32 v118, v140, v141
    v_cvt_pk_bf16_f32 v119, v142, v143
    s_mov_b32 exec_lo, 0
    v_mov_b32 v118, 0
    v_mov_b32 v119, 0
    s_mov_b32 exec_lo, -1
    buffer_store_dwordx4 v[116:119], v1, s[24:27], s64 offen offset:1024 sc1
    v_maximum3_f32 v51, abs(v128), abs(v129), abs(v130)
    v_maximum3_f32 v51, v51, abs(v131), abs(v132)
    v_maximum3_f32 v51, v51, abs(v133), abs(v134)
    v_maximum3_f32 v51, v51, abs(v135), abs(v136)
    v_maximum3_f32 v51, v51, abs(v137), abs(v138)
    v_maximum3_f32 v51, v51, abs(v139), abs(v140)
    v_maximum3_f32 v51, v51, abs(v141), abs(v142)
    v_maximum3_f32 v51, v51, abs(v143), abs(v143)
    s_mov_b32 s65, 0x7f000000
    v_cmp_nlt_f32 vcc, v51, s65
    s_cmp_lg_u32 s66, 0
    s_cbranch_scc1 L_ka_st
    s_nop 2
    s_cmp_lg_u64 vcc, 0
    s_cbranch_scc1 L_ka_slow
L_ka_st:
    s_min_u32 s40, s35, 6
    s_mul_i32 s41, s40, 28672
    s_lshl_b32 s42, s8, 7
    s_add_u32 s41, s41, s42
    s_add_u32 s41, s41, 200704
    s_lshl_b32 s40, s40, 11
    s_add_u32 m0, s40, 32768
    s_nop 0
    buffer_load_dwordx4 v236, s[16:19], s41 offen lds
    s_add_u32 m0, s40, 47104
    s_nop 0
    buffer_load_dwordx4 v237, s[16:19], s41 offen lds
    s_add_u32 s41, s41, 14336
    s_add_u32 m0, s40, 33792
    s_nop 0
    buffer_load_dwordx4 v236, s[16:19], s41 offen lds
    s_add_u32 m0, s40, 48128
    s_nop 0
    buffer_load_dwordx4 v237, s[16:19], s41 offen lds
    v_readfirstlane_b32 s40, v235
    v_add_u32 v238, 1, v233
    s_lshl_b32 s41, s10, 2
    s_lshr_b32 s41, 0x1204, s41
    s_and_b32 s41, s41, 15
    s_lshl_b32 s41, s41, 15
    v_bfe_u32 v9, v2, 2, 2
    v_lshlrev_b32 v7, 6, v9
    v_bfe_u32 v9, v2, 4, 1
    v_lshl_add_u32 v7, v9, 5, v7
    v_and_b32 v9, 3, v2
    v_lshl_add_u32 v7, v9, 3, v7
    v_add_u32 v7, s41, v7
    v_lshl_add_u32 v8, v4, 8, v7
    v_mov_b32 v16, 0
    v_mov_b32 v17, 0
    v_mov_b32 v18, 0
    v_mov_b32 v19, 0
    v_mov_b32 v20, 0
    v_mov_b32 v21, 0
    v_mov_b32 v22, 0
    v_mov_b32 v23, 0
    v_mov_b32 v24, 0
    v_mov_b32 v25, 0
    v_mov_b32 v26, 0
    v_mov_b32 v27, 0
    v_mov_b32 v28, 0
    v_mov_b32 v29, 0
    v_mov_b32 v30, 0
    v_mov_b32 v31, 0
    v_mov_b32 v32, 0
    v_mov_b32 v33, 0
    v_mov_b32 v34, 0
    v_mov_b32 v35, 0
    v_mov_b32 v36, 0
    v_mov_b32 v37, 0
    v_mov_b32 v38, 0
    v_mov_b32 v39, 0
    v_mov_b32 v40, 0
    v_mov_b32 v41, 0
    v_mov_b32 v42, 0
    v_mov_b32 v43, 0
    v_mov_b32 v44, 0
    v_mov_b32 v45, 0
    v_mov_b32 v46, 0
    v_mov_b32 v47, 0
    s_lshl_b32 s42, s9, 16
    s_lshl_b32 s41, s10, 14
    s_add_u32 s42, s42, s41
    s_add_u32 s42, s42, 8388608
    s_cmp_lg_u32 s40, 0
    s_cbranch_scc0 L_ka_regspin
L_ka_regok:
    s_waitcnt vmcnt(4)
    s_mov_b64 exec, 1
    buffer_store_dword v238, v234, s[24:27], s11 offen sc1
    s_mov_b64 exec, -1
    s_cmp_ge_u32 s2, 224
    s_cbranch_scc1 L_ka_done
    s_waitcnt vmcnt(1)
    s_barrier
    s_mov_b32 s61, 0
    v_mov_b32 v10, 159744
    s_and_b32 s50, s35, 1
    s_lshl_b32 s50, s50, 5
    s_lshl_b32 s51, s10, 3
    s_add_u32 s50, s50, s51
    s_cmp_lg_u32 s35, 0
    s_cbranch_scc1 L_ka_p3lds
L_ka_p3spin:
    buffer_load_dword v9, v239, s[24:27], s11 offen sc1
    s_waitcnt vmcnt(0)
    v_cmp_ne_u32 vcc, v9, v240
    s_add_u32 s61, s61, 1
    s_nop 3
    v_mov_b32 v12, vcc_lo
    v_mov_b32 v13, vcc_hi
    ds_write_b64 v10, v[12:13] offset:80
    s_cmp_eq_u64 vcc, -1
    s_cbranch_scc1 L_ka_p3go
    s_cmp_ge_u32 s61, 0x100000
    s_cbranch_scc1 L_ka_p3go
    s_sleep 4
    s_branch L_ka_p3spin
L_ka_p3lds:
    ds_read_b64 v[12:13], v10 offset:80
    s_waitcnt lgkmcnt(0)
    v_readfirstlane_b32 s4, v12
    v_readfirstlane_b32 s5, v13
    s_add_u32 s61, s61, 1
    s_nop 1
    s_lshr_b64 s[4:5], s[4:5], s50
    s_and_b32 s4, s4, 0xff
    s_cmp_eq_u32 s4, 0xff
    s_cbranch_scc1 L_ka_p3go
    s_cmp_ge_u32 s61, 0x1000000
    s_cbranch_scc1 L_ka_p3go
    s_sleep 1
    s_branch L_ka_p3lds
L_ka_p3go:
    buffer_load_dwordx4 v[64:67], v1, s[24:27], s42 offen offset:0 sc1
    buffer_load_dwordx4 v[68:71], v1, s[24:27], s42 offen offset:1024 sc1
    buffer_load_dwordx4 v[72:75], v1, s[24:27], s42 offen offset:2048 sc1
    buffer_load_dwordx4 v[76:79], v1, s[24:27], s42 offen offset:3072 sc1
    s_add_u32 s42, s42, 4096
    buffer_load_dwordx4 v[80:83], v1, s[24:27], s42 offen offset:0 sc1
    buffer_load_dwordx4 v[84:87], v1, s[24:27], s42 offen offset:1024 sc1
    buffer_load_dwordx4 v[88:91], v1, s[24:27], s42 offen offset:2048 sc1
    buffer_load_dwordx4 v[92:95], v1, s[24:27], s42 offen offset:3072 sc1
    s_add_u32 s42, s42, 4096
    buffer_load_dwordx4 v[96:99], v1, s[24:27], s42 offen offset:0 sc1
    buffer_load_dwordx4 v[100:103], v1, s[24:27], s42 offen offset:1024 sc1
    buffer_load_dwordx4 v[104:107], v1, s[24:27], s42 offen offset:2048 sc1
    buffer_load_dwordx4 v[108:111], v1, s[24:27], s42 offen offset:3072 sc1
    s_add_u32 s42, s42, 4096
    buffer_load_dwordx4 v[112:115], v1, s[24:27], s42 offen offset:0 sc1
    buffer_load_dwordx4 v[116:119], v1, s[24:27], s42 offen offset:1024 sc1
    buffer_load_dwordx4 v[120:123], v1, s[24:27], s42 offen offset:2048 sc1
    buffer_load_dwordx4 v[124:127], v1, s[24:27], s42 offen offset:3072 sc1
    ds_read_b64_tr_b16 v[136:137], v8 offset:0
    ds_read_b64_tr_b16 v[138:139], v8 offset:512
    ds_read_b64_tr_b16 v[140:141], v8 offset:14336
    ds_read_b64_tr_b16 v[142:143], v8 offset:14848
    s_lshl_b32 s40, s35, 13
    s_and_b32 s41, s35, 1
    s_lshl_b32 s40, s41, 15
    s_lshl_b32 s50, s10, 13
    s_add_u32 s50, s50, s40
    v_add_u32 v10, s50, v1
    s_and_b32 s50, s10, 1
    s_lshr_b32 s51, s10, 1
    s_lshl_b32 s41, s50, 12
    s_add_u32 s40, s40, s41
    s_lshl_b32 s41, s51, 11
    s_add_u32 s40, s40, s41
    v_add_u32 v11, s40, v1
    v_mul_u32_u24 v12, 896, v3
    v_lshl_add_u32 v12, v4, 4, v12
    s_mul_i32 s40, s9, 28672
    s_lshl_b32 s41, s8, 7
    s_add_u32 s40, s40, s41
    s_lshl_b32 s41, s50, 6
    s_add_u32 s40, s40, s41
    s_lshl_b32 s41, s51, 5
    s_add_u32 s40, s40, s41
    ds_read_b64_tr_b16 v[144:145], v8 offset:1024
    ds_read_b64_tr_b16 v[146:147], v7 offset:1536
    ds_read_b64_tr_b16 v[148:149], v8 offset:15360
    ds_read_b64_tr_b16 v[150:151], v7 offset:15872
    s_waitcnt vmcnt(15) lgkmcnt(4)
    v_mfma_f32_32x32x16_bf16 v[16:31], v[136:139], v[64:67], v[16:31]
    v_mfma_f32_32x32x16_bf16 v[32:47], v[140:143], v[64:67], v[32:47]
    ds_read_b64_tr_b16 v[136:137], v8 offset:1792
    ds_read_b64_tr_b16 v[138:139], v8 offset:2304
    ds_read_b64_tr_b16 v[140:141], v8 offset:16128
    ds_read_b64_tr_b16 v[142:143], v8 offset:16640
    s_waitcnt vmcnt(14) lgkmcnt(4)
    v_mfma_f32_32x32x16_bf16 v[16:31], v[144:147], v[68:71], v[16:31]
    v_mfma_f32_32x32x16_bf16 v[32:47], v[148:151], v[68:71], v[32:47]
    ds_read_b64_tr_b16 v[144:145], v8 offset:2816
    ds_read_b64_tr_b16 v[146:147], v7 offset:3328
    ds_read_b64_tr_b16 v[148:149], v8 offset:17152
    ds_read_b64_tr_b16 v[150:151], v7 offset:17664
    s_waitcnt vmcnt(13) lgkmcnt(4)
    v_mfma_f32_32x32x16_bf16 v[16:31], v[136:139], v[72:75], v[16:31]
    v_mfma_f32_32x32x16_bf16 v[32:47], v[140:143], v[72:75], v[32:47]
    ds_read_b64_tr_b16 v[136:137], v8 offset:3584
    ds_read_b64_tr_b16 v[138:139], v8 offset:4096
    ds_read_b64_tr_b16 v[140:141], v8 offset:17920
    ds_read_b64_tr_b16 v[142:143], v8 offset:18432
    s_waitcnt vmcnt(12) lgkmcnt(4)
    v_mfma_f32_32x32x16_bf16 v[16:31], v[144:147], v[76:79], v[16:31]
    v_mfma_f32_32x32x16_bf16 v[32:47], v[148:151], v[76:79], v[32:47]
    ds_read_b64_tr_b16 v[144:145], v8 offset:4608
    ds_read_b64_tr_b16 v[146:147], v7 offset:5120
    ds_read_b64_tr_b16 v[148:149], v8 offset:18944
    ds_read_b64_tr_b16 v[150:151], v7 offset:19456
    s_waitcnt vmcnt(11) lgkmcnt(4)
    v_mfma_f32_32x32x16_bf16 v[16:31], v[136:139], v[80:83], v[16:31]
    v_mfma_f32_32x32x16_bf16 v[32:47], v[140:143], v[80:83], v[32:47]
    ds_read_b64_tr_b16 v[136:137], v8 offset:5376
    ds_read_b64_tr_b16 v[138:139], v8 offset:5888
    ds_read_b64_tr_b16 v[140:141], v8 offset:19712
    ds_read_b64_tr_b16 v[142:143], v8 offset:20224
    s_waitcnt vmcnt(10) lgkmcnt(4)
    v_mfma_f32_32x32x16_bf16 v[16:31], v[144:147], v[84:87], v[16:31]
    v_mfma_f32_32x32x16_bf16 v[32:47], v[148:151], v[84:87], v[32:47]
    ds_read_b64_tr_b16 v[144:145], v8 offset:6400
    ds_read_b64_tr_b16 v[146:147], v7 offset:6912
    ds_read_b64_tr_b16 v[148:149], v8 offset:20736
    ds_read_b64_tr_b16 v[150:151], v7 offset:21248
    s_waitcnt vmcnt(9) lgkmcnt(4)
    v_mfma_f32_32x32x16_bf16 v[16:31], v[136:139], v[88:91], v[16:31]
    v_mfma_f32_32x32x16_bf16 v[32:47], v[140:143], v[88:91], v[32:47]
    ds_read_b64_tr_b16 v[136:137], v8 offset:7168
    ds_read_b64_tr_b16 v[138:139], v8 offset:7680
    ds_read_b64_tr_b16 v[140:141], v8 offset:21504
    ds_read_b64_tr_b16 v[142:143], v8 offset:22016
    s_waitcnt vmcnt(8) lgkmcnt(4)
    v_mfma_f32_32x32x16_bf16 v[16:31], v[144:147], v[92:95], v[16:31]
    v_mfma_f32_32x32x16_bf16 v[32:47], v[148:151], v[92:95], v[32:47]
    ds_read_b64_tr_b16 v[144:145], v8 offset:8192
    ds_read_b64_tr_b16 v[146:147], v7 offset:8704
    ds_read_b64_tr_b16 v[148:149], v8 offset:22528
    ds_read_b64_tr_b16 v[150:151], v7 offset:23040
    s_waitcnt vmcnt(7) lgkmcnt(4)
    v_mfma_f32_32x32x16_bf16 v[16:31], v[136:139], v[96:99], v[16:31]
    v_mfma_f32_32x32x16_bf16 v[32:47], v[140:143], v[96:99], v[32:47]
    ds_read_b64_tr_b16 v[136:137], v8 offset:8960
    ds_read_b64_tr_b16 v[138:139], v8 offset:9472
    ds_read_b64_tr_b16 v[140:141], v8 offset:23296
    ds_read_b64_tr_b16 v[142:143], v8 offset:23808
    s_waitcnt vmcnt(6) lgkmcnt(4)
    v_mfma_f32_32x32x16_bf16 v[16:31], v[144:147], v[100:103], v[16:31]
    v_mfma_f32_32x32x16_bf16 v[32:47], v[148:151], v[100:103], v[32:47]
    ds_read_b64_tr_b16 v[144:145], v8 offset:9984
    ds_read_b64_tr_b16 v[146:147], v7 offset:10496
    ds_read_b64_tr_b16 v[148:149], v8 offset:24320
    ds_read_b64_tr_b16 v[150:151], v7 offset:24832
    s_waitcnt vmcnt(5) lgkmcnt(4)
    v_mfma_f32_32x32x16_bf16 v[16:31], v[136:139], v[104:107], v[16:31]
    v_mfma_f32_32x32x16_bf16 v[32:47], v[140:143], v[104:107], v[32:47]
    ds_read_b64_tr_b16 v[136:137], v8 offset:10752
    ds_read_b64_tr_b16 v[138:139], v8 offset:11264
    ds_read_b64_tr_b16 v[140:141], v8 offset:25088
    ds_read_b64_tr_b16 v[142:143], v8 offset:25600
    s_waitcnt vmcnt(4) lgkmcnt(4)
    v_mfma_f32_32x32x16_bf16 v[16:31], v[144:147], v[108:111], v[16:31]
    v_mfma_f32_32x32x16_bf16 v[32:47], v[148:151], v[108:111], v[32:47]
    ds_read_b64_tr_b16 v[144:145], v8 offset:11776
    ds_read_b64_tr_b16 v[146:147], v7 offset:12288
    ds_read_b64_tr_b16 v[148:149], v8 offset:26112
    ds_read_b64_tr_b16 v[150:151], v7 offset:26624
    s_waitcnt vmcnt(3) lgkmcnt(4)
    v_mfma_f32_32x32x16_bf16 v[16:31], v[136:139], v[112:115], v[16:31]
    v_mfma_f32_32x32x16_bf16 v[32:47], v[140:143], v[112:115], v[32:47]
    ds_read_b64_tr_b16 v[136:137], v8 offset:12544
    ds_read_b64_tr_b16 v[138:139], v8 offset:13056
    ds_read_b64_tr_b16 v[140:141], v8 offset:26880
    ds_read_b64_tr_b16 v[142:143], v8 offset:27392
    s_waitcnt vmcnt(2) lgkmcnt(4)
    v_mfma_f32_32x32x16_bf16 v[16:31], v[144:147], v[116:119], v[16:31]
    v_mfma_f32_32x32x16_bf16 v[32:47], v[148:151], v[116:119], v[32:47]
    ds_read_b64_tr_b16 v[144:145], v8 offset:13568
    ds_read_b64_tr_b16 v[146:147], v7 offset:14080
    ds_read_b64_tr_b16 v[148:149], v8 offset:27904
    ds_read_b64_tr_b16 v[150:151], v7 offset:28416
    s_waitcnt vmcnt(1) lgkmcnt(4)
    v_mfma_f32_32x32x16_bf16 v[16:31], v[136:139], v[120:123], v[16:31]
    v_mfma_f32_32x32x16_bf16 v[32:47], v[140:143], v[120:123], v[32:47]
    s_waitcnt vmcnt(0) lgkmcnt(0)
    v_mfma_f32_32x32x16_bf16 v[16:31], v[144:147], v[124:127], v[16:31]
    v_mfma_f32_32x32x16_bf16 v[32:47], v[148:151], v[124:127], v[32:47]
    s_barrier
    s_nop 7
    s_nop 3
    ds_write_b128 v10, v[16:19] offset:0
    ds_write_b128 v10, v[20:23] offset:1024
    ds_write_b128 v10, v[24:27] offset:2048
    ds_write_b128 v10, v[28:31] offset:3072
    ds_write_b128 v10, v[32:35] offset:4096
    ds_write_b128 v10, v[36:39] offset:5120
    ds_write_b128 v10, v[40:43] offset:6144
    ds_write_b128 v10, v[44:47] offset:7168
    s_waitcnt lgkmcnt(0)
    s_barrier
    ds_read_b128 v[64:67], v11 offset:0
    ds_read_b128 v[68:71], v11 offset:1024
    ds_read_b128 v[72:75], v11 offset:8192
    ds_read_b128 v[76:79], v11 offset:9216
    ds_read_b128 v[80:83], v11 offset:16384
    ds_read_b128 v[84:87], v11 offset:17408
    ds_read_b128 v[88:91], v11 offset:24576
    ds_read_b128 v[92:95], v11 offset:25600
    s_waitcnt lgkmcnt(4)
    v_add_f32 v64, v64, v72
    v_add_f32 v65, v65, v73
    v_add_f32 v66, v66, v74
    v_add_f32 v67, v67, v75
    v_add_f32 v68, v68, v76
    v_add_f32 v69, v69, v77
    v_add_f32 v70, v70, v78
    v_add_f32 v71, v71, v79
    s_waitcnt lgkmcnt(0)
    v_add_f32 v80, v80, v88
    v_add_f32 v81, v81, v89
    v_add_f32 v82, v82, v90
    v_add_f32 v83, v83, v91
    v_add_f32 v84, v84, v92
    v_add_f32 v85, v85, v93
    v_add_f32 v86, v86, v94
    v_add_f32 v87, v87, v95
    v_add_f32 v64, v64, v80
    v_add_f32 v65, v65, v81
    v_add_f32 v66, v66, v82
    v_add_f32 v67, v67, v83
    v_add_f32 v68, v68, v84
    v_add_f32 v69, v69, v85
    v_add_f32 v70, v70, v86
    v_add_f32 v71, v71, v87
    v_cvt_pk_bf16_f32 v16, v64, v65
    v_cvt_pk_bf16_f32 v17, v66, v67
    v_cvt_pk_bf16_f32 v18, v68, v69
    v_cvt_pk_bf16_f32 v19, v70, v71
    s_nop 1
    v_permlane32_swap_b32 v16, v18
    v_permlane32_swap_b32 v17, v19
    s_nop 1
    buffer_store_dwordx4 v[16:19], v12, s[52:55], s40 offen
L_ka_done:
L_ka_end:
    s_endpgm
L_ka_w0:
    s_waitcnt vmcnt(0)
    s_barrier
    s_branch L_ka_w1
L_ka_sidein:
    s_cmp_eq_u32 s45, 5
    s_cbranch_scc1 L_ka_x4
L_ka_x4r:
    s_cmp_ge_u32 s45, 6
    s_cbranch_scc1 L_ka_nodma
    s_and_b32 s40, s46, s62
    s_cbranch_scc1 L_ka_fl1978_ok
    s_mov_b32 s61, 0
    v_mov_b32 v8, 159808
L_ka_fl1978_spin:
    s_cmp_lg_u32 s35, s65
    s_cbranch_scc1 L_ka_fl1978_lds
    buffer_load_dword v11, v225, s[24:27], s3 offen sc1
    v_mov_b32 v9, 0
    s_and_b32 s41, s61, 7
    s_cmp_lg_u32 s41, 7
    s_cbranch_scc1 L_ka_fl1978_nodbg
    buffer_load_dword v9, v9, s[56:59], s63 offen sc1
L_ka_fl1978_nodbg:
    s_waitcnt vmcnt(0)
    v_cmp_ne_u32 vcc, v11, v224
    s_nop 4
    s_or_b32 s41, vcc_lo, s46
    v_or_b32 v11, s41, v9
    v_and_b32 v11, 0xff, v11
    ds_write_b32 v8, v11
    s_add_u32 s61, s61, 16
    s_branch L_ka_fl1978_chk
L_ka_fl1978_lds:
    ds_read_b32 v11, v8
    s_waitcnt lgkmcnt(0)
L_ka_fl1978_chk:
    v_readfirstlane_b32 s46, v11
    s_add_u32 s61, s61, 1
    s_mov_b32 s40, s62
    s_cmp_ge_u32 s61, 0x1000000
    s_cbranch_scc1 L_ka_fl1978_ok
    s_and_b32 s40, s46, s62
    s_cbranch_scc1 L_ka_fl1978_ok
    s_sleep 1
    s_branch L_ka_fl1978_spin
L_ka_fl1978_ok:
    s_lshl_b32 s41, s40, 8
    s_or_b32 s40, s40, s41
    s_lshr_b32 s40, s40, s33
    s_ff1_i32_b32 s40, s40
    s_add_u32 s40, s40, s33
    s_and_b32 s40, s40, 7
    s_bitset0_b32 s62, s40
    s_lshl_b32 s40, s40, 15
    s_add_u32 s40, s40, s49
    s_lshl_b32 s41, s60, 2
    s_lshr_b32 s41, 0x13201320, s41
    s_and_b32 s41, s41, 15
    s_lshl_b32 s41, s41, 15
    s_add_u32 m0, s41, s49
    s_add_u32 s60, s60, 1
    buffer_load_dwordx4 v1, s[20:23], s40 offen offset:0 sc1 lds
    buffer_load_dwordx4 v1, s[20:23], s40 offen offset:1024 sc1 lds
    buffer_load_dwordx4 v1, s[20:23], s40 offen offset:2048 sc1 lds
    buffer_load_dwordx4 v1, s[20:23], s40 offen offset:3072 sc1 lds
L_ka_nodma:
    s_bitcmp1_b32 0x7e, s45
    s_cbranch_scc1 L_ka_side
L_ka_nodma2:
    s_cmp_eq_u32 s43, 0
    s_cbranch_scc1 L_ka_ret0
    s_branch L_ka_ret1
L_ka_x4:
    s_cmp_lg_u32 s35, s65
    s_cbranch_scc1 L_ka_x4r
    v_lshlrev_b32 v235, 2, v2
    buffer_load_dword v235, v235, s[56:59], 0 offen sc1
    s_branch L_ka_x4r
L_ka_side:
    s_cmp_eq_u32 s45, 3
    s_cbranch_scc1 L_ka_s3
    s_cmp_eq_u32 s45, 4
    s_cbranch_scc1 L_ka_s4
    s_cmp_eq_u32 s45, 5
    s_cbranch_scc1 L_ka_s5
    s_cmp_eq_u32 s45, 6
    s_cbranch_scc1 L_ka_s6
    s_cmp_lg_u32 s35, 1
    s_cbranch_scc1 L_ka_nodma2
    s_and_b32 s41, s33, 1
    s_add_u32 s41, s41, 1
    s_cmp_lg_u32 s41, s45
    s_cbranch_scc1 L_ka_nodma2
    s_lshl_b32 s41, 0x101, s33
    v_mov_b32 v9, s41
    v_mov_b32 v11, 0
    s_mov_b64 exec, 1
    buffer_atomic_or v9, v11, s[56:59], s63 offen sc1
    s_mov_b64 exec, -1
    s_branch L_ka_nodma2
L_ka_s3:
    s_min_u32 s40, s35, 6
    s_mul_i32 s41, s40, 28672
    s_lshl_b32 s42, s8, 7
    s_add_u32 s41, s41, s42
    s_lshl_b32 s40, s40, 11
    s_add_u32 m0, s40, 131072
    s_nop 0
    buffer_load_dwordx4 v236, s[12:15], s41 offen lds
    s_add_u32 m0, s40, 145408
    s_nop 0
    buffer_load_dwordx4 v237, s[12:15], s41 offen lds
    s_add_u32 s41, s41, 14336
    s_add_u32 m0, s40, 132096
    s_nop 0
    buffer_load_dwordx4 v236, s[12:15], s41 offen lds
    s_add_u32 m0, s40, 146432
    s_nop 0
    buffer_load_dwordx4 v237, s[12:15], s41 offen lds
    s_branch L_ka_nodma2
L_ka_s4:
    s_min_u32 s40, s35, 6
    s_mul_i32 s41, s40, 28672
    s_lshl_b32 s42, s8, 7
    s_add_u32 s41, s41, s42
    s_add_u32 s41, s41, 200704
    s_lshl_b32 s40, s40, 11
    buffer_load_dwordx4 v[228:231], v236, s[16:19], s41 offen
    s_add_u32 s41, s41, 14336
    buffer_load_dwordx4 v[228:231], v236, s[16:19], s41 offen
    s_branch L_ka_nodma2
L_ka_s5:
    s_min_u32 s40, s35, 6
    s_mul_i32 s41, s40, 28672
    s_lshl_b32 s42, s8, 7
    s_add_u32 s41, s41, s42
    s_add_u32 s41, s41, 200704
    s_lshl_b32 s40, s40, 11
    s_add_u32 m0, s40, 0
    s_nop 0
    buffer_load_dwordx4 v236, s[12:15], s41 offen lds
    s_add_u32 m0, s40, 14336
    s_nop 0
    buffer_load_dwordx4 v237, s[12:15], s41 offen lds
    s_add_u32 s41, s41, 14336
    s_add_u32 m0, s40, 1024
    s_nop 0
    buffer_load_dwordx4 v236, s[12:15], s41 offen lds
    s_add_u32 m0, s40, 15360
    s_nop 0
    buffer_load_dwordx4 v237, s[12:15], s41 offen lds
    s_branch L_ka_nodma2
L_ka_s6:
    s_min_u32 s40, s35, 6
    s_mul_i32 s41, s40, 28672
    s_lshl_b32 s42, s8, 7
    s_add_u32 s41, s41, s42
    s_lshl_b32 s40, s40, 11
    s_add_u32 m0, s40, 65536
    s_nop 0
    buffer_load_dwordx4 v236, s[16:19], s41 offen lds
    s_add_u32 m0, s40, 79872
    s_nop 0
    buffer_load_dwordx4 v237, s[16:19], s41 offen lds
    s_add_u32 s41, s41, 14336
    s_add_u32 m0, s40, 66560
    s_nop 0
    buffer_load_dwordx4 v236, s[16:19], s41 offen lds
    s_add_u32 m0, s40, 80896
    s_nop 0
    buffer_load_dwordx4 v237, s[16:19], s41 offen lds
    s_cmp_lg_u32 s35, s65
    s_cbranch_scc1 L_ka_nodma2
    v_bfe_u32 v235, v235, 8, 8
    v_mov_b32 v9, 0xff
    v_cmp_eq_u32 vcc, v235, v9
    v_mov_b32 v9, 159744
    v_mov_b32 v11, 1
    s_nop 3
    s_and_b32 s40, vcc_lo, vcc_hi
    s_and_b32 s40, s40, 0x55555555
    s_cmp_lg_u32 s40, 0x55555555
    s_cbranch_scc1 L_ka_nodma2
    ds_write_b32 v9, v11 offset:68
    s_branch L_ka_nodma2
L_ka_regspin:
    s_mov_b32 s61, 0
L_ka_regspin2:
    v_lshlrev_b32 v235, 2, v2
    buffer_load_dword v235, v235, s[56:59], 0 offen sc1
    v_mov_b32 v9, 0xff
    s_waitcnt vmcnt(0)
    v_bfe_u32 v235, v235, 8, 8
    v_cmp_eq_u32 vcc, v235, v9
    s_add_u32 s61, s61, 1
    s_nop 3
    s_and_b32 s40, vcc_lo, vcc_hi
    s_and_b32 s40, s40, 0x55555555
    s_cmp_eq_u32 s40, 0x55555555
    s_cbranch_scc1 L_ka_regok
    s_cmp_ge_u32 s61, 0x100000
    s_cbranch_scc1 L_ka_regok
    s_sleep 8
    s_branch L_ka_regspin2
L_ka_slow:
    s_waitcnt vmcnt(0) lgkmcnt(0)
    v_mov_b32 v32, 0
    v_mov_b32 v16, 0
    v_mov_b32 v33, 0
    v_mov_b32 v17, 0
    v_mov_b32 v34, 0
    v_mov_b32 v18, 0
    v_mov_b32 v35, 0
    v_mov_b32 v19, 0
    v_mov_b32 v36, 0
    v_mov_b32 v20, 0
    v_mov_b32 v37, 0
    v_mov_b32 v21, 0
    v_mov_b32 v38, 0
    v_mov_b32 v22, 0
    v_mov_b32 v39, 0
    v_mov_b32 v23, 0
    v_mov_b32 v40, 0
    v_mov_b32 v24, 0
    v_mov_b32 v41, 0
    v_mov_b32 v25, 0
    v_mov_b32 v42, 0
    v_mov_b32 v26, 0
    v_mov_b32 v43, 0
    v_mov_b32 v27, 0
    v_mov_b32 v44, 0
    v_mov_b32 v28, 0
    v_mov_b32 v45, 0
    v_mov_b32 v29, 0
    v_mov_b32 v46, 0
    v_mov_b32 v30, 0
    v_mov_b32 v47, 0
    v_mov_b32 v31, 0
    v_mov_b32 v53, 0xff7fffff
L_ka_slow_loop:
    buffer_load_dwordx4 v[176:179], v1, s[20:23], s66 offen sc1
    buffer_load_dwordx4 v[180:183], v1, s[20:23], s66 offen offset:1024 sc1
    buffer_load_dwordx4 v[192:195], v1, s[20:23], s66 offen offset:2048 sc1
    buffer_load_dwordx4 v[196:199], v1, s[20:23], s66 offen offset:3072 sc1
    s_waitcnt vmcnt(0)
    v_mfma_f32_32x32x16_bf16 v[112:127], v[176:179], v[72:75], 0
    v_mfma_f32_32x32x16_bf16 v[112:127], v[180:183], v[76:79], v[112:127]
    s_nop 15
    s_nop 3
    v_max3_f32 v48, v112, v113, v114
    v_max3_f32 v48, v48, v115, v116
    v_max3_f32 v48, v48, v117, v118
    v_max3_f32 v48, v48, v119, v120
    v_max3_f32 v48, v48, v121, v122
    v_max3_f32 v48, v48, v123, v124
    v_max3_f32 v48, v48, v125, v126
    v_max_f32 v48, v48, v127
    v_mov_b32 v49, v48
    s_nop 1
    v_permlane32_swap_b32 v48, v49
    s_nop 1
    v_max3_f32 v48, v48, v49, v53
    v_sub_f32 v49, v53, v48
    v_exp_f32 v49, v49
    v_mov_b32 v53, v48
    v_sub_f32 v112, v112, v48
    v_sub_f32 v113, v113, v48
    v_sub_f32 v114, v114, v48
    v_sub_f32 v115, v115, v48
    v_sub_f32 v116, v116, v48
    v_sub_f32 v117, v117, v48
    v_sub_f32 v118, v118, v48
    v_sub_f32 v119, v119, v48
    v_sub_f32 v120, v120, v48
    v_sub_f32 v121, v121, v48
    v_sub_f32 v122, v122, v48
    v_sub_f32 v123, v123, v48
    v_sub_f32 v124, v124, v48
    v_sub_f32 v125, v125, v48
    v_sub_f32 v126, v126, v48
    v_sub_f32 v127, v127, v48
    v_exp_f32 v112, v112
    v_exp_f32 v113, v113
    v_exp_f32 v114, v114
    v_exp_f32 v115, v115
    v_exp_f32 v116, v116
    v_exp_f32 v117, v117
    v_exp_f32 v118, v118
    v_exp_f32 v119, v119
    v_exp_f32 v120, v120
    v_exp_f32 v121, v121
    v_exp_f32 v122, v122
    v_exp_f32 v123, v123
    v_exp_f32 v124, v124
    v_exp_f32 v125, v125
    v_exp_f32 v126, v126
    v_exp_f32 v127, v127
    v_mul_f32 v32, v32, v49
    v_mul_f32 v33, v33, v49
    v_mul_f32 v34, v34, v49
    v_mul_f32 v35, v35, v49
    v_mul_f32 v36, v36, v49
    v_mul_f32 v37, v37, v49
    v_mul_f32 v38, v38, v49
    v_mul_f32 v39, v39, v49
    v_mul_f32 v40, v40, v49
    v_mul_f32 v41, v41, v49
    v_mul_f32 v42, v42, v49
    v_mul_f32 v43, v43, v49
    v_mul_f32 v44, v44, v49
    v_mul_f32 v45, v45, v49
    v_mul_f32 v46, v46, v49
    v_mul_f32 v47, v47, v49
    s_nop 3
    v_smfmac_f32_32x32x32_bf16 v[32:47], v[192:195], v[112:119], v5
    v_smfmac_f32_32x32x32_bf16 v[32:47], v[196:199], v[120:127], v5
    s_nop 15
    s_nop 3
    s_add_u32 s66, s66, 4096
    s_cmp_lt_u32 s66, 262144
    s_cbranch_scc1 L_ka_slow_loop
    s_branch L_ka_fin
L_ka_last:
.section .rodata,"a"
.p2align 6
.amdhsa_kernel gated_mix__softmax_full_mha__softmax_full_mha__prompt_kernel
  .amdhsa_next_free_vgpr 248
  .amdhsa_next_free_sgpr 68
  .amdhsa_accum_offset 248
  .amdhsa_group_segment_fixed_size 0
  .amdhsa_kernarg_size 80
  .amdhsa_user_sgpr_count 2
  .amdhsa_user_sgpr_kernarg_segment_ptr 1
  .amdhsa_system_sgpr_workgroup_id_x 1
.end_amdhsa_kernel
```
